```python
import torch

def _softmax(x, axis=-1):
    return torch.softmax(x, dim=axis)
def _gelu(x):
    return torch.nn.functional.gelu(x, approximate="tanh")
def _silu(x):
    return torch.nn.functional.silu(x)
def _sigmoid(x):
    return torch.sigmoid(x)
def _layernorm(x, axis=-1, eps=1e-5):
    m = x.mean(dim=axis, keepdim=True)
    v = x.var(dim=axis, keepdim=True, unbiased=False)
    return (x - m) / torch.sqrt(v + eps)
def _scatter_add(tgt, idx, src, axis=0):
    return tgt.clone().index_add_(axis, idx, src)
def _segment_sum(src, seg, n):
    out = torch.zeros((n,) + src.shape[1:], dtype=src.dtype)
    return out.index_add_(0, seg, src)
def _pad(x, pw):
    flat = tuple(v for pair in reversed(pw) for v in pair)
    return torch.nn.functional.pad(x, flat)

kernel_name = 'standalone__gqa_block_cached__near_ridge'

def setup_inputs():

    _w = (lambda a: (lambda t: t.to(torch.bfloat16) if t.is_floating_point() else t)(torch.as_tensor(a)))
    B, Sq, D = 8, 144, 640
    Hq, Hkv, Sk, Dh = 32, 32, 1024, 128
    assert Hq % Hkv == 0, (Hq, Hkv)
    return {
        "x": _w((lambda *s: torch.randn(*s, dtype=torch.bfloat16) * 0.8)(B, Sq, D)),
        "k_cache": _w((lambda *s: torch.randn(*s, dtype=torch.bfloat16) * 0.8)(B, Hkv, Sk, Dh)),
        "v_cache": _w((lambda *s: torch.randn(*s, dtype=torch.bfloat16) * 0.05)(B, Hkv, Sk, Dh)),
        "wq": _w((lambda *s: torch.randn(*s, dtype=torch.bfloat16) * 0.8)(D, Hq * Dh) * (D ** -0.5)),
        "wo": _w((lambda *s: torch.randn(*s, dtype=torch.bfloat16) * 0.05)(Hq * Dh, D) * ((Hq * Dh) ** -0.5)),
    }

def reference(x, k_cache, v_cache, wq, wo):
    B, Sq, D = x.shape
    Hq, Dh = 32, 128
    Hkv = k_cache.shape[1]
    rep = Hq // Hkv
    q = (lambda x, *d: x.permute(*d))((x @ wq).reshape(B, Sq, Hq, Dh), 0, 2, 1, 3)
    k = (lambda x, n, axis: torch.repeat_interleave(x, n, dim=axis))(k_cache, rep, axis=1)
    v = (lambda x, n, axis: torch.repeat_interleave(x, n, dim=axis))(v_cache, rep, axis=1)
    scores = torch.einsum("bhqd,bhkd->bhqk", q, k) * (Dh ** -0.5)
    p = _softmax(scores, axis=-1)
    o = torch.einsum("bhqk,bhkd->bhqd", p, v)
    return (lambda x, *d: x.permute(*d))(o, 0, 2, 1, 3).reshape(B, Sq, Hq * Dh) @ wo
```

```asm
; @launch grid=(256,1,1) block=(512,1,1) lds=163840
.amdgcn_target "amdgcn-amd-amdhsa--gfx950"
.text
.globl standalone__gqa_block_cached__near_ridge_kernel
.p2align 8
.type standalone__gqa_block_cached__near_ridge_kernel,@function
standalone__gqa_block_cached__near_ridge_kernel:
    s_cmp_ge_u32 s2, 256
    s_cbranch_scc1 L_end
    s_load_dwordx8 s[4:11], s[0:1], 0
    s_load_dwordx8 s[12:19], s[0:1], 32
    v_lshrrev_b32 v1, 6, v0
    v_and_b32 v255, 63, v0
    s_lshr_b32 s41, s2, 5
    v_readfirstlane_b32 s40, v1
    s_and_b32 s42, s2, 31
    s_mov_b32 s56, s40
    s_cmp_lt_u32 s40, 4
    s_cbranch_scc1 L_dry
    s_sub_u32 s59, s40, 4
    v_lshrrev_b32 v64, 3, v255
    v_mul_u32_u24 v192, 1280, v64
    v_and_b32 v65, 7, v255
    v_lshrrev_b32 v66, 4, v255
    v_xor_b32 v65, v65, v66
    s_lshl_b32 s43, s59, 2
    v_xor_b32 v65, s43, v65
    v_lshl_add_u32 v192, v65, 4, v192
    v_lshlrev_b32 v67, 1, v66
    v_and_b32 v68, 15, v255
    v_xor_b32 v67, v67, v68
    v_lshlrev_b32 v193, 13, v66
    v_lshl_add_u32 v193, v67, 4, v193
    s_mul_i32 s44, s59, 10240
    v_add_u32 v192, s44, v192
    s_lshl_b32 s44, s59, 18
    v_add_u32 v193, s44, v193
    v_xor_b32 v194, 128, v193
    s_lshl_b32 s45, s59, 10
    s_lshl_b32 s47, s59, 13
    s_add_u32 s47, s47, 18432
    s_lshr_b32 s48, s42, 3
    s_mul_i32 s48, s48, 3
    s_add_u32 s48, s48, s41
    s_sub_u32 s49, s48, 10
    s_cmp_ge_u32 s48, 10
    s_cselect_b32 s48, s49, s48
    s_lshl_b32 s49, s48, 19
    s_lshl_b32 s48, s48, 7
    s_mul_i32 s43, s41, 184320
    s_lshl_b32 s51, s42, 8
    s_waitcnt lgkmcnt(0)
    s_add_u32 s20, s4, s43
    s_addc_u32 s21, s5, 0
    s_mov_b32 s22, 184320
    s_mov_b32 s23, 0x20000
    s_add_u32 s24, s10, s51
    s_addc_u32 s25, s11, 0
    s_sub_u32 s26, 5242880, s51
    s_mov_b32 s27, 0x20000
    s_cmp_ge_u32 s59, 2
    s_cbranch_scc1 L_h_common
    s_add_u32 m0, s45, 102400
    s_add_u32 s52, s48, 0
    buffer_load_dwordx4 v192, s[20:23], s52 offen lds
    s_add_u32 m0, s47, 102400
    s_add_u32 s52, s49, 0
    buffer_load_dwordx4 v193, s[24:27], s52 offen lds
    s_add_u32 m0, s45, 104448
    s_add_u32 s52, s48, 20480
    buffer_load_dwordx4 v192, s[20:23], s52 offen lds
    s_add_u32 m0, s47, 103424
    s_add_u32 s52, s49, 32768
    buffer_load_dwordx4 v193, s[24:27], s52 offen lds
    s_add_u32 m0, s45, 106496
    s_add_u32 s52, s48, 40960
    buffer_load_dwordx4 v192, s[20:23], s52 offen lds
    s_add_u32 m0, s47, 104448
    s_add_u32 s52, s49, 65536
    buffer_load_dwordx4 v194, s[24:27], s52 offen lds
    s_add_u32 m0, s45, 108544
    s_add_u32 s52, s48, 61440
    buffer_load_dwordx4 v192, s[20:23], s52 offen lds
    s_add_u32 m0, s47, 105472
    s_add_u32 s52, s49, 98304
    buffer_load_dwordx4 v194, s[24:27], s52 offen lds
    s_add_u32 m0, s45, 110592
    s_add_u32 s52, s48, 81920
    buffer_load_dwordx4 v192, s[20:23], s52 offen lds
    s_add_u32 m0, s47, 106496
    s_add_u32 s52, s49, 131072
    buffer_load_dwordx4 v193, s[24:27], s52 offen lds
    s_add_u32 m0, s45, 112640
    s_add_u32 s52, s48, 102400
    buffer_load_dwordx4 v192, s[20:23], s52 offen lds
    s_add_u32 m0, s47, 107520
    s_add_u32 s52, s49, 163840
    buffer_load_dwordx4 v193, s[24:27], s52 offen lds
    s_add_u32 m0, s45, 114688
    s_add_u32 s52, s48, 122880
    buffer_load_dwordx4 v192, s[20:23], s52 offen lds
    s_add_u32 m0, s47, 108544
    s_add_u32 s52, s49, 196608
    buffer_load_dwordx4 v194, s[24:27], s52 offen lds
    s_add_u32 m0, s45, 116736
    s_add_u32 s52, s48, 143360
    buffer_load_dwordx4 v192, s[20:23], s52 offen lds
    s_add_u32 m0, s47, 109568
    s_add_u32 s52, s49, 229376
    buffer_load_dwordx4 v194, s[24:27], s52 offen lds
    s_add_u32 m0, s45, 118784
    s_add_u32 s52, s48, 163840
    buffer_load_dwordx4 v192, s[20:23], s52 offen lds
    s_add_u32 s48, s48, 128
    s_add_u32 s49, s49, 524288
    s_cmp_ge_u32 s48, 1280
    s_cselect_b32 s48, 0, s48
    s_cselect_b32 s49, 0, s49
    s_add_u32 m0, s45, 32768
    s_add_u32 s52, s48, 0
    buffer_load_dwordx4 v192, s[20:23], s52 offen lds
    s_add_u32 m0, s47, 32768
    s_add_u32 s52, s49, 0
    buffer_load_dwordx4 v193, s[24:27], s52 offen lds
    s_add_u32 m0, s45, 34816
    s_add_u32 s52, s48, 20480
    buffer_load_dwordx4 v192, s[20:23], s52 offen lds
    s_add_u32 m0, s47, 33792
    s_add_u32 s52, s49, 32768
    buffer_load_dwordx4 v193, s[24:27], s52 offen lds
    s_add_u32 m0, s45, 36864
    s_add_u32 s52, s48, 40960
    buffer_load_dwordx4 v192, s[20:23], s52 offen lds
    s_add_u32 m0, s47, 34816
    s_add_u32 s52, s49, 65536
    buffer_load_dwordx4 v194, s[24:27], s52 offen lds
    s_add_u32 m0, s45, 38912
    s_add_u32 s52, s48, 61440
    buffer_load_dwordx4 v192, s[20:23], s52 offen lds
    s_add_u32 m0, s47, 35840
    s_add_u32 s52, s49, 98304
    buffer_load_dwordx4 v194, s[24:27], s52 offen lds
    s_add_u32 m0, s45, 40960
    s_add_u32 s52, s48, 81920
    buffer_load_dwordx4 v192, s[20:23], s52 offen lds
    s_add_u32 m0, s47, 36864
    s_add_u32 s52, s49, 131072
    buffer_load_dwordx4 v193, s[24:27], s52 offen lds
    s_add_u32 m0, s45, 43008
    s_add_u32 s52, s48, 102400
    buffer_load_dwordx4 v192, s[20:23], s52 offen lds
    s_add_u32 m0, s47, 37888
    s_add_u32 s52, s49, 163840
    buffer_load_dwordx4 v193, s[24:27], s52 offen lds
    s_add_u32 m0, s45, 45056
    s_add_u32 s52, s48, 122880
    buffer_load_dwordx4 v192, s[20:23], s52 offen lds
    s_add_u32 m0, s47, 38912
    s_add_u32 s52, s49, 196608
    buffer_load_dwordx4 v194, s[24:27], s52 offen lds
    s_add_u32 m0, s45, 47104
    s_add_u32 s52, s48, 143360
    buffer_load_dwordx4 v192, s[20:23], s52 offen lds
    s_add_u32 m0, s47, 39936
    s_add_u32 s52, s49, 229376
    buffer_load_dwordx4 v194, s[24:27], s52 offen lds
    s_add_u32 m0, s45, 49152
    s_add_u32 s52, s48, 163840
    buffer_load_dwordx4 v192, s[20:23], s52 offen lds
    s_add_u32 s48, s48, 128
    s_add_u32 s49, s49, 524288
    s_cmp_ge_u32 s48, 1280
    s_cselect_b32 s48, 0, s48
    s_cselect_b32 s49, 0, s49
L_h_common:
    s_lshl_b32 s3, s2, 18
    s_waitcnt lgkmcnt(0)
    s_add_u32 s28, s6, s3
    s_addc_u32 s29, s7, 0
    s_mov_b32 s30, 0x40000
    s_mov_b32 s31, 0x20000
    s_add_u32 s32, s8, s3
    s_addc_u32 s33, s9, 0
    s_mov_b32 s34, 0x40000
    s_mov_b32 s35, 0x20000
    s_lshl_b32 s50, s59, 12
    v_bfe_u32 v64, v255, 2, 2
    v_and_b32 v65, 3, v255
    v_bfe_u32 v66, v255, 4, 1
    v_lshrrev_b32 v68, 4, v255
    v_and_b32 v70, 15, v255
    v_lshlrev_b32 v69, 8, v68
    v_add_u32 v69, s50, v69
    v_lshlrev_b32 v71, 1, v68
    v_xor_b32 v71, v71, v70
    v_lshl_add_u32 v108, v71, 4, v69
    v_xor_b32 v109, 128, v108
    v_xor_b32 v71, v70, v68
    v_xor_b32 v111, 0, v71
    v_lshl_add_u32 v104, v111, 4, v69
    v_xor_b32 v111, 4, v71
    v_lshl_add_u32 v105, v111, 4, v69
L_stub0:
    s_cbranch_execz L_dry_back
    v_xor_b32 v111, 8, v71
    v_lshl_add_u32 v106, v111, 4, v69
    v_xor_b32 v111, 12, v71
    v_lshl_add_u32 v107, v111, 4, v69
    s_lshr_b32 s62, s59, 1
    s_and_b32 s43, s59, 1
    s_lshl_b32 s43, s43, 5
    v_add_u32 v69, s43, v70
    v_lshlrev_b32 v69, 8, v69
    v_add_u32 v69, 137216, v69
    v_xor_b32 v111, 0, v71
    v_lshl_add_u32 v112, v111, 4, v69
    v_xor_b32 v111, 4, v71
    v_lshl_add_u32 v113, v111, 4, v69
    v_xor_b32 v111, 8, v71
    v_lshl_add_u32 v114, v111, 4, v69
    v_xor_b32 v111, 12, v71
    v_lshl_add_u32 v115, v111, 4, v69
    v_lshl_add_u32 v69, v68, 2, v64
    v_add_u32 v69, s43, v69
    v_lshlrev_b32 v69, 8, v69
    v_add_u32 v69, 16384, v69
    v_and_b32 v71, 1, v65
    v_lshl_add_u32 v69, v71, 3, v69
    v_lshl_add_u32 v70, v66, 2, v64
    v_lshrrev_b32 v111, 1, v65
    v_lshl_add_u32 v70, v70, 1, v111
    v_xor_b32 v111, 0, v70
    v_lshl_add_u32 v116, v111, 4, v69
    v_xor_b32 v111, 2, v70
    v_lshl_add_u32 v117, v111, 4, v69
    v_xor_b32 v111, 4, v70
    v_lshl_add_u32 v118, v111, 4, v69
    v_xor_b32 v111, 6, v70
    v_lshl_add_u32 v119, v111, 4, v69
    v_xor_b32 v111, 8, v70
    v_lshl_add_u32 v120, v111, 4, v69
    v_xor_b32 v111, 10, v70
    v_lshl_add_u32 v121, v111, 4, v69
    v_xor_b32 v111, 12, v70
    v_lshl_add_u32 v122, v111, 4, v69
    v_xor_b32 v111, 14, v70
    v_lshl_add_u32 v123, v111, 4, v69
L_stub1:
    s_cbranch_execz L_dry_back
    v_mov_b32 v0, 0
    v_mov_b32 v1, 0
    v_mov_b32 v2, 0
    v_mov_b32 v3, 0
    v_mov_b32 v4, 0
    v_mov_b32 v5, 0
    v_mov_b32 v6, 0
    v_mov_b32 v7, 0
    v_mov_b32 v8, 0
    v_mov_b32 v9, 0
    v_mov_b32 v10, 0
    v_mov_b32 v11, 0
    v_mov_b32 v12, 0
    v_mov_b32 v13, 0
    v_mov_b32 v14, 0
    v_mov_b32 v15, 0
    v_mov_b32 v16, 0
    v_mov_b32 v17, 0
    v_mov_b32 v18, 0
    v_mov_b32 v19, 0
    v_mov_b32 v20, 0
    v_mov_b32 v21, 0
    v_mov_b32 v22, 0
    v_mov_b32 v23, 0
    v_mov_b32 v24, 0
    v_mov_b32 v25, 0
    v_mov_b32 v26, 0
    v_mov_b32 v27, 0
    v_mov_b32 v28, 0
    v_mov_b32 v29, 0
    v_mov_b32 v30, 0
    v_mov_b32 v31, 0
    v_mov_b32 v96, 0
    v_mov_b32 v48, 0
    v_mov_b32 v100, 0x3f803f80
    v_mov_b32 v97, 0
    v_mov_b32 v49, 0
    v_mov_b32 v101, 0x3f803f80
    v_mov_b32 v98, 0
    v_mov_b32 v50, 0
    v_mov_b32 v102, 0x3f803f80
    v_mov_b32 v99, 0
    v_mov_b32 v51, 0
    v_mov_b32 v103, 0x3f803f80
    v_mov_b32 v132, 0
    v_mov_b32 v131, 1
    v_and_b32 v133, 7, v255
    v_lshlrev_b32 v133, 2, v133
    s_cmp_ge_u32 s59, 2
    s_cbranch_scc1 L_h_q23
    s_waitcnt vmcnt(17)
    s_barrier
    s_add_u32 m0, s45, 67584
    s_add_u32 s52, s48, 0
    buffer_load_dwordx4 v192, s[20:23], s52 offen lds
    s_add_u32 m0, s47, 67584
L_stub2:
    s_cbranch_execz L_dry_back
    s_add_u32 s52, s49, 0
    buffer_load_dwordx4 v193, s[24:27], s52 offen lds
    s_add_u32 m0, s45, 69632
    s_add_u32 s52, s48, 20480
    buffer_load_dwordx4 v192, s[20:23], s52 offen lds
    s_add_u32 m0, s47, 68608
    s_add_u32 s52, s49, 32768
    buffer_load_dwordx4 v193, s[24:27], s52 offen lds
    s_add_u32 m0, s45, 71680
    s_add_u32 s52, s48, 40960
    buffer_load_dwordx4 v192, s[20:23], s52 offen lds
    s_add_u32 m0, s47, 69632
    s_add_u32 s52, s49, 65536
    buffer_load_dwordx4 v194, s[24:27], s52 offen lds
    s_add_u32 m0, s45, 73728
    s_add_u32 s52, s48, 61440
    buffer_load_dwordx4 v192, s[20:23], s52 offen lds
    s_add_u32 m0, s47, 70656
    s_add_u32 s52, s49, 98304
    buffer_load_dwordx4 v194, s[24:27], s52 offen lds
    s_add_u32 m0, s45, 75776
    s_add_u32 s52, s48, 81920
    buffer_load_dwordx4 v192, s[20:23], s52 offen lds
    s_add_u32 m0, s47, 71680
    s_add_u32 s52, s49, 131072
    buffer_load_dwordx4 v193, s[24:27], s52 offen lds
    s_add_u32 m0, s45, 77824
    s_add_u32 s52, s48, 102400
    buffer_load_dwordx4 v192, s[20:23], s52 offen lds
    s_add_u32 m0, s47, 72704
    s_add_u32 s52, s49, 163840
    buffer_load_dwordx4 v193, s[24:27], s52 offen lds
L_stub3:
    s_cbranch_execz L_dry_back
    s_add_u32 m0, s45, 79872
    s_add_u32 s52, s48, 122880
    buffer_load_dwordx4 v192, s[20:23], s52 offen lds
    s_add_u32 m0, s47, 73728
    s_add_u32 s52, s49, 196608
    buffer_load_dwordx4 v194, s[24:27], s52 offen lds
    s_add_u32 m0, s45, 81920
    s_add_u32 s52, s48, 143360
    buffer_load_dwordx4 v192, s[20:23], s52 offen lds
    s_add_u32 m0, s47, 74752
    s_add_u32 s52, s49, 229376
    buffer_load_dwordx4 v194, s[24:27], s52 offen lds
    s_add_u32 m0, s45, 83968
    s_add_u32 s52, s48, 163840
    buffer_load_dwordx4 v192, s[20:23], s52 offen lds
    s_add_u32 s48, s48, 128
    s_add_u32 s49, s49, 524288
    s_cmp_ge_u32 s48, 1280
    s_cselect_b32 s48, 0, s48
    s_cselect_b32 s49, 0, s49
    s_waitcnt vmcnt(17)
    s_barrier
    s_add_u32 m0, s45, 102400
    s_add_u32 s52, s48, 0
    buffer_load_dwordx4 v192, s[20:23], s52 offen lds
    s_add_u32 m0, s47, 102400
    s_add_u32 s52, s49, 0
    buffer_load_dwordx4 v193, s[24:27], s52 offen lds
    s_add_u32 m0, s45, 104448
    s_add_u32 s52, s48, 20480
    buffer_load_dwordx4 v192, s[20:23], s52 offen lds
    s_add_u32 m0, s47, 103424
    s_add_u32 s52, s49, 32768
    buffer_load_dwordx4 v193, s[24:27], s52 offen lds
    s_add_u32 m0, s45, 106496
L_stub4:
    s_cbranch_execz L_dry_back
    s_add_u32 s52, s48, 40960
    buffer_load_dwordx4 v192, s[20:23], s52 offen lds
    s_add_u32 m0, s47, 104448
    s_add_u32 s52, s49, 65536
    buffer_load_dwordx4 v194, s[24:27], s52 offen lds
    s_add_u32 m0, s45, 108544
    s_add_u32 s52, s48, 61440
    buffer_load_dwordx4 v192, s[20:23], s52 offen lds
    s_add_u32 m0, s47, 105472
    s_add_u32 s52, s49, 98304
    buffer_load_dwordx4 v194, s[24:27], s52 offen lds
    s_add_u32 m0, s45, 110592
    s_add_u32 s52, s48, 81920
    buffer_load_dwordx4 v192, s[20:23], s52 offen lds
    s_add_u32 m0, s47, 106496
    s_add_u32 s52, s49, 131072
    buffer_load_dwordx4 v193, s[24:27], s52 offen lds
    s_add_u32 m0, s45, 112640
    s_add_u32 s52, s48, 102400
    buffer_load_dwordx4 v192, s[20:23], s52 offen lds
    s_add_u32 m0, s47, 107520
    s_add_u32 s52, s49, 163840
    buffer_load_dwordx4 v193, s[24:27], s52 offen lds
    s_add_u32 m0, s45, 114688
    s_add_u32 s52, s48, 122880
    buffer_load_dwordx4 v192, s[20:23], s52 offen lds
    s_add_u32 m0, s47, 108544
    s_add_u32 s52, s49, 196608
    buffer_load_dwordx4 v194, s[24:27], s52 offen lds
    s_add_u32 m0, s45, 116736
    s_add_u32 s52, s48, 143360
L_stub5:
    s_cbranch_execz L_dry_back
    buffer_load_dwordx4 v192, s[20:23], s52 offen lds
    s_add_u32 m0, s47, 109568
    s_add_u32 s52, s49, 229376
    buffer_load_dwordx4 v194, s[24:27], s52 offen lds
    s_add_u32 m0, s45, 118784
    s_add_u32 s52, s48, 163840
    buffer_load_dwordx4 v192, s[20:23], s52 offen lds
    s_add_u32 s48, s48, 128
    s_add_u32 s49, s49, 524288
    s_cmp_ge_u32 s48, 1280
    s_cselect_b32 s48, 0, s48
    s_cselect_b32 s49, 0, s49
    s_add_u32 m0, s50, 137216
    s_nop 0
    buffer_load_dwordx4 v104, s[28:31], 0 offen offset:0 nt lds
    buffer_load_dwordx4 v105, s[28:31], 0 offen offset:1024 nt lds
    buffer_load_dwordx4 v106, s[28:31], 0 offen offset:2048 nt lds
    buffer_load_dwordx4 v107, s[28:31], 0 offen offset:3072 nt lds
    v_add_u32 v104, 16384, v104
    v_add_u32 v105, 16384, v105
    v_add_u32 v106, 16384, v106
    v_add_u32 v107, 16384, v107
    s_waitcnt vmcnt(21)
    s_barrier
    s_add_u32 m0, s45, 32768
    s_add_u32 s52, s48, 0
    buffer_load_dwordx4 v192, s[20:23], s52 offen lds
    s_add_u32 m0, s47, 32768
    s_add_u32 s52, s49, 0
    buffer_load_dwordx4 v193, s[24:27], s52 offen lds
    s_add_u32 m0, s45, 34816
    s_add_u32 s52, s48, 20480
    buffer_load_dwordx4 v192, s[20:23], s52 offen lds
    s_add_u32 m0, s47, 33792
    s_add_u32 s52, s49, 32768
L_stub6:
    s_cbranch_execz L_dry_back
    buffer_load_dwordx4 v193, s[24:27], s52 offen lds
    s_add_u32 m0, s45, 36864
    s_add_u32 s52, s48, 40960
    buffer_load_dwordx4 v192, s[20:23], s52 offen lds
    s_add_u32 m0, s47, 34816
    s_add_u32 s52, s49, 65536
    buffer_load_dwordx4 v194, s[24:27], s52 offen lds
    s_add_u32 m0, s45, 38912
    s_add_u32 s52, s48, 61440
    buffer_load_dwordx4 v192, s[20:23], s52 offen lds
    s_add_u32 m0, s47, 35840
    s_add_u32 s52, s49, 98304
    buffer_load_dwordx4 v194, s[24:27], s52 offen lds
    s_add_u32 m0, s45, 40960
    s_add_u32 s52, s48, 81920
    buffer_load_dwordx4 v192, s[20:23], s52 offen lds
    s_add_u32 m0, s47, 36864
    s_add_u32 s52, s49, 131072
    buffer_load_dwordx4 v193, s[24:27], s52 offen lds
    s_add_u32 m0, s45, 43008
    s_add_u32 s52, s48, 102400
    buffer_load_dwordx4 v192, s[20:23], s52 offen lds
    s_add_u32 m0, s47, 37888
    s_add_u32 s52, s49, 163840
    buffer_load_dwordx4 v193, s[24:27], s52 offen lds
    s_add_u32 m0, s45, 45056
    s_add_u32 s52, s48, 122880
    buffer_load_dwordx4 v192, s[20:23], s52 offen lds
    s_add_u32 m0, s47, 38912
    s_add_u32 s52, s49, 196608
    buffer_load_dwordx4 v194, s[24:27], s52 offen lds
    s_add_u32 m0, s45, 47104
L_stub7:
    s_cbranch_execz L_dry_back
    s_add_u32 s52, s48, 143360
    buffer_load_dwordx4 v192, s[20:23], s52 offen lds
    s_add_u32 m0, s47, 39936
    s_add_u32 s52, s49, 229376
    buffer_load_dwordx4 v194, s[24:27], s52 offen lds
    s_add_u32 m0, s45, 49152
    s_add_u32 s52, s48, 163840
    buffer_load_dwordx4 v192, s[20:23], s52 offen lds
    s_add_u32 s48, s48, 128
    s_add_u32 s49, s49, 524288
    s_cmp_ge_u32 s48, 1280
    s_cselect_b32 s48, 0, s48
    s_cselect_b32 s49, 0, s49
    s_waitcnt vmcnt(21)
    s_barrier
    s_add_u32 m0, s45, 67584
    s_add_u32 s52, s48, 0
    buffer_load_dwordx4 v192, s[20:23], s52 offen lds
    s_add_u32 m0, s47, 67584
    s_add_u32 s52, s49, 0
    buffer_load_dwordx4 v193, s[24:27], s52 offen lds
    s_add_u32 m0, s45, 69632
    s_add_u32 s52, s48, 20480
    buffer_load_dwordx4 v192, s[20:23], s52 offen lds
    s_add_u32 m0, s47, 68608
    s_add_u32 s52, s49, 32768
    buffer_load_dwordx4 v193, s[24:27], s52 offen lds
    s_add_u32 m0, s45, 71680
    s_add_u32 s52, s48, 40960
    buffer_load_dwordx4 v192, s[20:23], s52 offen lds
    s_add_u32 m0, s47, 69632
    s_add_u32 s52, s49, 65536
    buffer_load_dwordx4 v194, s[24:27], s52 offen lds
    s_add_u32 m0, s45, 73728
L_stub8:
    s_cbranch_execz L_dry_back
    s_add_u32 s52, s48, 61440
    buffer_load_dwordx4 v192, s[20:23], s52 offen lds
    s_add_u32 m0, s47, 70656
    s_add_u32 s52, s49, 98304
    buffer_load_dwordx4 v194, s[24:27], s52 offen lds
    s_add_u32 m0, s45, 75776
    s_add_u32 s52, s48, 81920
    buffer_load_dwordx4 v192, s[20:23], s52 offen lds
    s_add_u32 m0, s47, 71680
    s_add_u32 s52, s49, 131072
    buffer_load_dwordx4 v193, s[24:27], s52 offen lds
    s_add_u32 m0, s45, 77824
    s_add_u32 s52, s48, 102400
    buffer_load_dwordx4 v192, s[20:23], s52 offen lds
    s_add_u32 m0, s47, 72704
    s_add_u32 s52, s49, 163840
    buffer_load_dwordx4 v193, s[24:27], s52 offen lds
    s_add_u32 m0, s45, 79872
    s_add_u32 s52, s48, 122880
    buffer_load_dwordx4 v192, s[20:23], s52 offen lds
    s_add_u32 m0, s47, 73728
    s_add_u32 s52, s49, 196608
    buffer_load_dwordx4 v194, s[24:27], s52 offen lds
    s_add_u32 m0, s45, 81920
    s_add_u32 s52, s48, 143360
    buffer_load_dwordx4 v192, s[20:23], s52 offen lds
    s_add_u32 m0, s47, 74752
    s_add_u32 s52, s49, 229376
    buffer_load_dwordx4 v194, s[24:27], s52 offen lds
    s_add_u32 m0, s45, 83968
    s_add_u32 s52, s48, 163840
    buffer_load_dwordx4 v192, s[20:23], s52 offen lds
L_stub9:
    s_cbranch_execz L_dry_back
    s_add_u32 s48, s48, 128
    s_add_u32 s49, s49, 524288
    s_cmp_ge_u32 s48, 1280
    s_cselect_b32 s48, 0, s48
    s_cselect_b32 s49, 0, s49
    s_waitcnt vmcnt(17)
    s_barrier
    s_add_u32 m0, s45, 102400
    s_add_u32 s52, s48, 0
    buffer_load_dwordx4 v192, s[20:23], s52 offen lds
    s_add_u32 m0, s47, 102400
    s_add_u32 s52, s49, 0
    buffer_load_dwordx4 v193, s[24:27], s52 offen lds
    s_add_u32 m0, s45, 104448
    s_add_u32 s52, s48, 20480
    buffer_load_dwordx4 v192, s[20:23], s52 offen lds
    s_add_u32 m0, s47, 103424
    s_add_u32 s52, s49, 32768
    buffer_load_dwordx4 v193, s[24:27], s52 offen lds
    s_add_u32 m0, s45, 106496
    s_add_u32 s52, s48, 40960
    buffer_load_dwordx4 v192, s[20:23], s52 offen lds
    s_add_u32 m0, s47, 104448
    s_add_u32 s52, s49, 65536
    buffer_load_dwordx4 v194, s[24:27], s52 offen lds
    s_add_u32 m0, s45, 108544
    s_add_u32 s52, s48, 61440
    buffer_load_dwordx4 v192, s[20:23], s52 offen lds
    s_add_u32 m0, s47, 105472
    s_add_u32 s52, s49, 98304
    buffer_load_dwordx4 v194, s[24:27], s52 offen lds
    s_add_u32 m0, s45, 110592
    s_add_u32 s52, s48, 81920
    buffer_load_dwordx4 v192, s[20:23], s52 offen lds
L_stub10:
    s_cbranch_execz L_dry_back
    s_add_u32 m0, s47, 106496
    s_add_u32 s52, s49, 131072
    buffer_load_dwordx4 v193, s[24:27], s52 offen lds
    s_add_u32 m0, s45, 112640
    s_add_u32 s52, s48, 102400
    buffer_load_dwordx4 v192, s[20:23], s52 offen lds
    s_add_u32 m0, s47, 107520
    s_add_u32 s52, s49, 163840
    buffer_load_dwordx4 v193, s[24:27], s52 offen lds
    s_add_u32 m0, s45, 114688
    s_add_u32 s52, s48, 122880
    buffer_load_dwordx4 v192, s[20:23], s52 offen lds
    s_add_u32 m0, s47, 108544
    s_add_u32 s52, s49, 196608
    buffer_load_dwordx4 v194, s[24:27], s52 offen lds
    s_add_u32 m0, s45, 116736
    s_add_u32 s52, s48, 143360
    buffer_load_dwordx4 v192, s[20:23], s52 offen lds
    s_add_u32 m0, s47, 109568
    s_add_u32 s52, s49, 229376
    buffer_load_dwordx4 v194, s[24:27], s52 offen lds
    s_add_u32 m0, s45, 118784
    s_add_u32 s52, s48, 163840
    buffer_load_dwordx4 v192, s[20:23], s52 offen lds
    s_add_u32 s48, s48, 128
    s_add_u32 s49, s49, 524288
    s_cmp_ge_u32 s48, 1280
    s_cselect_b32 s48, 0, s48
    s_cselect_b32 s49, 0, s49
    s_waitcnt vmcnt(17)
    s_barrier
    s_add_u32 m0, s45, 32768
    s_add_u32 s52, s48, 0
    buffer_load_dwordx4 v192, s[20:23], s52 offen lds
L_stub11:
    s_cbranch_execz L_dry_back
    s_add_u32 m0, s47, 32768
    s_add_u32 s52, s49, 0
    buffer_load_dwordx4 v193, s[24:27], s52 offen lds
    s_add_u32 m0, s45, 34816
    s_add_u32 s52, s48, 20480
    buffer_load_dwordx4 v192, s[20:23], s52 offen lds
    s_add_u32 m0, s47, 33792
    s_add_u32 s52, s49, 32768
    buffer_load_dwordx4 v193, s[24:27], s52 offen lds
    s_add_u32 m0, s45, 36864
    s_add_u32 s52, s48, 40960
    buffer_load_dwordx4 v192, s[20:23], s52 offen lds
    s_add_u32 m0, s47, 34816
    s_add_u32 s52, s49, 65536
    buffer_load_dwordx4 v194, s[24:27], s52 offen lds
    s_add_u32 m0, s45, 38912
    s_add_u32 s52, s48, 61440
    buffer_load_dwordx4 v192, s[20:23], s52 offen lds
    s_add_u32 m0, s47, 35840
    s_add_u32 s52, s49, 98304
    buffer_load_dwordx4 v194, s[24:27], s52 offen lds
    s_add_u32 m0, s45, 40960
    s_add_u32 s52, s48, 81920
    buffer_load_dwordx4 v192, s[20:23], s52 offen lds
    s_add_u32 m0, s47, 36864
    s_add_u32 s52, s49, 131072
    buffer_load_dwordx4 v193, s[24:27], s52 offen lds
    s_add_u32 m0, s45, 43008
    s_add_u32 s52, s48, 102400
    buffer_load_dwordx4 v192, s[20:23], s52 offen lds
    s_add_u32 m0, s47, 37888
    s_add_u32 s52, s49, 163840
L_stub12:
    s_cbranch_execz L_dry_back
    buffer_load_dwordx4 v193, s[24:27], s52 offen lds
    s_add_u32 m0, s45, 45056
    s_add_u32 s52, s48, 122880
    buffer_load_dwordx4 v192, s[20:23], s52 offen lds
    s_add_u32 m0, s47, 38912
    s_add_u32 s52, s49, 196608
    buffer_load_dwordx4 v194, s[24:27], s52 offen lds
    s_add_u32 m0, s45, 47104
    s_add_u32 s52, s48, 143360
    buffer_load_dwordx4 v192, s[20:23], s52 offen lds
    s_add_u32 m0, s47, 39936
    s_add_u32 s52, s49, 229376
    buffer_load_dwordx4 v194, s[24:27], s52 offen lds
    s_add_u32 m0, s45, 49152
    s_add_u32 s52, s48, 163840
    buffer_load_dwordx4 v192, s[20:23], s52 offen lds
    s_add_u32 s48, s48, 128
    s_add_u32 s49, s49, 524288
    s_cmp_ge_u32 s48, 1280
    s_cselect_b32 s48, 0, s48
    s_cselect_b32 s49, 0, s49
    s_waitcnt vmcnt(17)
    s_barrier
    s_add_u32 m0, s45, 67584
    s_add_u32 s52, s48, 0
    buffer_load_dwordx4 v192, s[20:23], s52 offen lds
    s_add_u32 m0, s47, 67584
    s_add_u32 s52, s49, 0
    buffer_load_dwordx4 v193, s[24:27], s52 offen lds
    s_add_u32 m0, s45, 69632
    s_add_u32 s52, s48, 20480
    buffer_load_dwordx4 v192, s[20:23], s52 offen lds
    s_add_u32 m0, s47, 68608
    s_add_u32 s52, s49, 32768
    buffer_load_dwordx4 v193, s[24:27], s52 offen lds
L_stub13:
    s_cbranch_execz L_dry_back
    s_add_u32 m0, s45, 71680
    s_add_u32 s52, s48, 40960
    buffer_load_dwordx4 v192, s[20:23], s52 offen lds
    s_add_u32 m0, s47, 69632
    s_add_u32 s52, s49, 65536
    buffer_load_dwordx4 v194, s[24:27], s52 offen lds
    s_add_u32 m0, s45, 73728
    s_add_u32 s52, s48, 61440
    buffer_load_dwordx4 v192, s[20:23], s52 offen lds
    s_add_u32 m0, s47, 70656
    s_add_u32 s52, s49, 98304
    buffer_load_dwordx4 v194, s[24:27], s52 offen lds
    s_add_u32 m0, s45, 75776
    s_add_u32 s52, s48, 81920
    buffer_load_dwordx4 v192, s[20:23], s52 offen lds
    s_add_u32 m0, s47, 71680
    s_add_u32 s52, s49, 131072
    buffer_load_dwordx4 v193, s[24:27], s52 offen lds
    s_add_u32 m0, s45, 77824
    s_add_u32 s52, s48, 102400
    buffer_load_dwordx4 v192, s[20:23], s52 offen lds
    s_add_u32 m0, s47, 72704
    s_add_u32 s52, s49, 163840
    buffer_load_dwordx4 v193, s[24:27], s52 offen lds
    s_add_u32 m0, s45, 79872
    s_add_u32 s52, s48, 122880
    buffer_load_dwordx4 v192, s[20:23], s52 offen lds
    s_add_u32 m0, s47, 73728
    s_add_u32 s52, s49, 196608
    buffer_load_dwordx4 v194, s[24:27], s52 offen lds
    s_add_u32 m0, s45, 81920
L_stub14:
    s_cbranch_execz L_dry_back
    s_add_u32 s52, s48, 143360
    buffer_load_dwordx4 v192, s[20:23], s52 offen lds
    s_add_u32 m0, s47, 74752
    s_add_u32 s52, s49, 229376
    buffer_load_dwordx4 v194, s[24:27], s52 offen lds
    s_add_u32 m0, s45, 83968
    s_add_u32 s52, s48, 163840
    buffer_load_dwordx4 v192, s[20:23], s52 offen lds
    s_add_u32 s48, s48, 128
    s_add_u32 s49, s49, 524288
    s_cmp_ge_u32 s48, 1280
    s_cselect_b32 s48, 0, s48
    s_cselect_b32 s49, 0, s49
    s_waitcnt vmcnt(17)
    s_barrier
    s_add_u32 m0, s45, 102400
    s_add_u32 s52, s48, 0
    buffer_load_dwordx4 v192, s[20:23], s52 offen lds
    s_add_u32 m0, s47, 102400
    s_add_u32 s52, s49, 0
    buffer_load_dwordx4 v193, s[24:27], s52 offen lds
    s_add_u32 m0, s45, 104448
    s_add_u32 s52, s48, 20480
    buffer_load_dwordx4 v192, s[20:23], s52 offen lds
    s_add_u32 m0, s47, 103424
    s_add_u32 s52, s49, 32768
    buffer_load_dwordx4 v193, s[24:27], s52 offen lds
    s_add_u32 m0, s45, 106496
    s_add_u32 s52, s48, 40960
    buffer_load_dwordx4 v192, s[20:23], s52 offen lds
    s_add_u32 m0, s47, 104448
    s_add_u32 s52, s49, 65536
    buffer_load_dwordx4 v194, s[24:27], s52 offen lds
    s_add_u32 m0, s45, 108544
    s_add_u32 s52, s48, 61440
L_stub15:
    s_cbranch_execz L_dry_back
    buffer_load_dwordx4 v192, s[20:23], s52 offen lds
    s_add_u32 m0, s47, 105472
    s_add_u32 s52, s49, 98304
    buffer_load_dwordx4 v194, s[24:27], s52 offen lds
    s_add_u32 m0, s45, 110592
    s_add_u32 s52, s48, 81920
    buffer_load_dwordx4 v192, s[20:23], s52 offen lds
    s_add_u32 m0, s47, 106496
    s_add_u32 s52, s49, 131072
    buffer_load_dwordx4 v193, s[24:27], s52 offen lds
    s_add_u32 m0, s45, 112640
    s_add_u32 s52, s48, 102400
    buffer_load_dwordx4 v192, s[20:23], s52 offen lds
    s_add_u32 m0, s47, 107520
    s_add_u32 s52, s49, 163840
    buffer_load_dwordx4 v193, s[24:27], s52 offen lds
    s_add_u32 m0, s45, 114688
    s_add_u32 s52, s48, 122880
    buffer_load_dwordx4 v192, s[20:23], s52 offen lds
    s_add_u32 m0, s47, 108544
    s_add_u32 s52, s49, 196608
    buffer_load_dwordx4 v194, s[24:27], s52 offen lds
    s_add_u32 m0, s45, 116736
    s_add_u32 s52, s48, 143360
    buffer_load_dwordx4 v192, s[20:23], s52 offen lds
    s_add_u32 m0, s47, 109568
    s_add_u32 s52, s49, 229376
    buffer_load_dwordx4 v194, s[24:27], s52 offen lds
    s_add_u32 m0, s45, 118784
    s_add_u32 s52, s48, 163840
    buffer_load_dwordx4 v192, s[20:23], s52 offen lds
L_stub16:
    s_cbranch_execz L_dry_back
    s_add_u32 s48, s48, 128
    s_add_u32 s49, s49, 524288
    s_cmp_ge_u32 s48, 1280
    s_cselect_b32 s48, 0, s48
    s_cselect_b32 s49, 0, s49
    s_waitcnt vmcnt(17)
    s_barrier
    s_add_u32 m0, s50, 0
    s_nop 0
    buffer_load_dwordx4 v104, s[28:31], 0 offen offset:0 nt lds
    buffer_load_dwordx4 v105, s[28:31], 0 offen offset:1024 nt lds
    buffer_load_dwordx4 v106, s[28:31], 0 offen offset:2048 nt lds
    buffer_load_dwordx4 v107, s[28:31], 0 offen offset:3072 nt lds
    v_add_u32 v104, 16384, v104
    v_add_u32 v105, 16384, v105
    v_add_u32 v106, 16384, v106
    v_add_u32 v107, 16384, v107
    s_waitcnt vmcnt(4)
    s_barrier
    s_add_u32 m0, s50, 16384
    s_nop 0
    buffer_load_dwordx4 v108, s[32:35], 0 offen offset:0 nt lds
    buffer_load_dwordx4 v109, s[32:35], 0 offen offset:1024 nt lds
    buffer_load_dwordx4 v108, s[32:35], 0 offen offset:2048 nt lds
    buffer_load_dwordx4 v109, s[32:35], 0 offen offset:3072 nt lds
    v_add_u32 v108, 16384, v108
    v_add_u32 v109, 16384, v109
    s_barrier
    s_branch L_h_q10
L_h_q23:
    s_mov_b32 s36, s18
    s_mov_b32 s37, s19
    s_mov_b32 s38, 16777216
    s_mov_b32 s39, 0x20000
    s_lshr_b32 s43, s2, 3
    s_lshl_b32 s43, s43, 2
    s_add_u32 s43, s43, s59
    s_cmp_lg_u32 s43, 127
    s_cbranch_scc1 L_h_noclr
    v_lshlrev_b32 v111, 4, v255
    s_and_b32 s44, s2, 7
    s_lshl_b32 s44, s44, 10
    s_add_u32 s44, s44, 12582912
L_stub17:
    s_cbranch_execz L_dry_back
    buffer_store_dwordx4 v[0:3], v111, s[36:39], s44 offen sc1
L_h_noclr:
    s_add_u32 s56, s59, 2
    s_branch L_dry
L_dry_ret_h:
    s_barrier
    s_barrier
    s_add_u32 m0, s50, 137216
    s_nop 0
    buffer_load_dwordx4 v104, s[28:31], 0 offen offset:0 nt lds
    buffer_load_dwordx4 v105, s[28:31], 0 offen offset:1024 nt lds
    buffer_load_dwordx4 v106, s[28:31], 0 offen offset:2048 nt lds
    buffer_load_dwordx4 v107, s[28:31], 0 offen offset:3072 nt lds
    v_add_u32 v104, 16384, v104
    v_add_u32 v105, 16384, v105
    v_add_u32 v106, 16384, v106
    v_add_u32 v107, 16384, v107
    s_barrier
    s_cmp_lg_u32 s43, 127
    s_cbranch_scc1 L_h_noann
    s_mov_b32 s20, s16
    s_mov_b32 s21, s17
    s_mov_b32 s22, 256
    s_mov_b32 s23, 0x20000
    v_mov_b32 v111, 1
    s_mov_b64 exec, 1
    s_waitcnt vmcnt(0)
    s_and_b32 s44, s2, 7
    s_lshl_b32 s44, s44, 2
    buffer_store_dword v111, v132, s[20:23], s44 offen sc1
    s_mov_b64 exec, -1
L_h_noann:
    s_barrier
    v_mov_b32 v64, -1
    v_mov_b32 v65, -1
    v_mov_b32 v66, -1
    v_mov_b32 v67, -1
    v_lshlrev_b32 v110, 4, v255
    s_mul_i32 s44, s2, 12288
    s_and_b32 s45, s59, 1
    s_mul_i32 s45, s45, 6144
    s_add_u32 s44, s44, s45
    s_add_u32 s44, s44, 13631488
    s_add_u32 s45, s44, 3072
    buffer_store_dwordx4 v[64:67], v110, s[36:39], s44 offen offset:0 sc1
    buffer_store_dwordx4 v[64:67], v110, s[36:39], s44 offen offset:1024 sc1
L_stub18:
    s_cbranch_execz L_dry_back
    buffer_store_dwordx4 v[64:67], v110, s[36:39], s44 offen offset:2048 sc1
    buffer_store_dwordx4 v[64:67], v110, s[36:39], s45 offen offset:0 sc1
    buffer_store_dwordx4 v[64:67], v110, s[36:39], s45 offen offset:1024 sc1
    buffer_store_dwordx4 v[64:67], v110, s[36:39], s45 offen offset:2048 sc1
    s_barrier
    s_barrier
    s_barrier
    s_barrier
    s_barrier
    s_add_u32 m0, s50, 0
    s_nop 0
    buffer_load_dwordx4 v104, s[28:31], 0 offen offset:0 nt lds
    buffer_load_dwordx4 v105, s[28:31], 0 offen offset:1024 nt lds
    buffer_load_dwordx4 v106, s[28:31], 0 offen offset:2048 nt lds
    buffer_load_dwordx4 v107, s[28:31], 0 offen offset:3072 nt lds
    v_add_u32 v104, 16384, v104
    v_add_u32 v105, 16384, v105
    v_add_u32 v106, 16384, v106
    v_add_u32 v107, 16384, v107
    s_barrier
    s_add_u32 m0, s50, 16384
    s_nop 0
    buffer_load_dwordx4 v108, s[32:35], 0 offen offset:0 nt lds
    buffer_load_dwordx4 v109, s[32:35], 0 offen offset:1024 nt lds
    buffer_load_dwordx4 v108, s[32:35], 0 offen offset:2048 nt lds
    buffer_load_dwordx4 v109, s[32:35], 0 offen offset:3072 nt lds
    v_add_u32 v108, 16384, v108
    v_add_u32 v109, 16384, v109
    s_waitcnt vmcnt(14)
    s_barrier
L_h_q10:
    s_mov_b32 s36, s18
    s_mov_b32 s37, s19
    s_mov_b32 s38, 16777216
    s_mov_b32 s39, 0x20000
    s_barrier
    s_add_u32 m0, s50, 32768
    s_nop 0
    buffer_load_dwordx4 v104, s[28:31], 0 offen offset:0 nt lds
    buffer_load_dwordx4 v105, s[28:31], 0 offen offset:1024 nt lds
L_stub19:
    s_cbranch_execz L_dry_back
    buffer_load_dwordx4 v106, s[28:31], 0 offen offset:2048 nt lds
    buffer_load_dwordx4 v107, s[28:31], 0 offen offset:3072 nt lds
    v_add_u32 v104, 16384, v104
    v_add_u32 v105, 16384, v105
    v_add_u32 v106, 16384, v106
    v_add_u32 v107, 16384, v107
    s_add_u32 m0, s50, 49152
    s_nop 0
    buffer_load_dwordx4 v108, s[32:35], 0 offen offset:0 nt lds
    buffer_load_dwordx4 v109, s[32:35], 0 offen offset:1024 nt lds
    buffer_load_dwordx4 v108, s[32:35], 0 offen offset:2048 nt lds
    buffer_load_dwordx4 v109, s[32:35], 0 offen offset:3072 nt lds
    v_add_u32 v108, 16384, v108
    v_add_u32 v109, 16384, v109
    s_lshr_b32 s43, s2, 3
    s_min_u32 s43, s43, 29
    s_mul_i32 s60, s43, 52
    s_lshr_b32 s60, s60, 8
    s_mul_i32 s61, s60, 5
    s_sub_u32 s61, s43, s61
    s_mov_b32 s63, 0
    s_and_b32 s43, s2, 4
    s_add_u32 s63, s63, s43
    s_and_b32 s63, s63, 7
    s_bfe_u32 s43, s2, 0x10002
    s_mul_i32 s43, s43, 6
    s_add_u32 s60, s60, s43
    s_bfe_u32 s43, s2, 0x10001
    s_mul_i32 s43, s43, 5
    s_add_u32 s61, s61, s43
    s_and_b32 s58, s2, 1
    s_mov_b32 s20, s12
    s_mov_b32 s21, s13
    s_mov_b32 s22, 5242880
    s_mov_b32 s23, 0x20000
    s_mov_b32 s24, s16
    s_mov_b32 s25, s17
    s_mov_b32 s26, 256
    s_mov_b32 s27, 0x20000
    v_lshrrev_b32 v64, 3, v255
    v_mul_u32_u24 v64, 1280, v64
    v_lshrrev_b32 v65, 4, v255
L_stub20:
    s_cbranch_execz L_dry_back
    v_lshlrev_b32 v65, 1, v65
    v_and_b32 v66, 7, v255
    v_xor_b32 v65, v65, v66
    v_lshl_add_u32 v130, v65, 4, v64
    s_lshl_b32 s46, s59, 14
    s_add_u32 s46, s46, 98304
    v_bfe_u32 v64, v255, 2, 2
    v_and_b32 v65, 3, v255
    v_bfe_u32 v66, v255, 4, 1
    v_lshrrev_b32 v68, 4, v255
    v_lshl_add_u32 v69, v68, 2, v64
    v_lshlrev_b32 v69, 7, v69
    v_and_b32 v70, 1, v65
    v_lshl_add_u32 v69, v70, 3, v69
    v_add_u32 v69, s46, v69
    v_and_b32 v70, 2, v64
    v_lshl_add_u32 v70, v66, 2, v70
    v_lshrrev_b32 v71, 1, v65
    v_or_b32 v70, v70, v71
    v_xor_b32 v71, 0, v70
    v_lshl_add_u32 v126, v71, 4, v69
    v_xor_b32 v71, 2, v70
    v_lshl_add_u32 v127, v71, 4, v69
    v_xor_b32 v71, 4, v70
    v_lshl_add_u32 v128, v71, 4, v69
    v_xor_b32 v71, 6, v70
    v_lshl_add_u32 v129, v71, 4, v69
    s_lshl_b32 s43, s58, 3
    s_add_u32 s43, s43, s40
    s_mul_i32 s47, s43, 327680
    s_lshl_b32 s43, s61, 7
    s_add_u32 s47, s47, s43
    s_lshl_b32 s43, s58, 3
    s_add_u32 s43, s43, s59
    s_mul_i32 s48, s43, 327680
    s_lshl_b32 s43, s61, 7
    s_add_u32 s48, s48, s43
    s_mov_b32 s49, s63
    s_mov_b32 s56, 0xff800000
    s_mov_b32 s57, 0xff800000
    s_add_u32 s51, s50, 65536
    s_mov_b32 s53, 0
    s_mov_b32 s45, 0
    s_mov_b32 s55, 2
    v_lshlrev_b32 v124, 4, v255
    v_add_u32 v124, 153600, v124
L_stub21:
    s_cbranch_execz L_dry_back
    s_waitcnt lgkmcnt(0)
    s_waitcnt vmcnt(8)
    s_barrier
    ds_read_b128 v[32:35], v124 offset:0
    ds_read_b128 v[36:39], v124 offset:1024
    ds_read_b128 v[40:43], v124 offset:2048
    ds_read_b128 v[44:47], v124 offset:3072
    s_waitcnt lgkmcnt(0)
    s_cmp_lg_u32 s62, 0
    s_cbranch_scc1 L_h_noqk0
    ds_read_b128 v[64:67], v112 offset:0
    ds_read_b128 v[68:71], v113 offset:0
    ds_read_b128 v[72:75], v114 offset:0
    ds_read_b128 v[76:79], v115 offset:0
    ds_read_b128 v[80:83], v112 offset:4096
    ds_read_b128 v[84:87], v113 offset:4096
    ds_read_b128 v[88:91], v114 offset:4096
    ds_read_b128 v[92:95], v115 offset:4096
    s_waitcnt lgkmcnt(7)
    v_mfma_f32_16x16x32_bf16 v[52:55], v[64:67], v[32:35], v[48:51]
    s_waitcnt lgkmcnt(6)
    v_mfma_f32_16x16x32_bf16 v[52:55], v[68:71], v[36:39], v[52:55]
    s_waitcnt lgkmcnt(5)
    v_mfma_f32_16x16x32_bf16 v[52:55], v[72:75], v[40:43], v[52:55]
    s_waitcnt lgkmcnt(4)
    v_mfma_f32_16x16x32_bf16 v[52:55], v[76:79], v[44:47], v[52:55]
    s_waitcnt lgkmcnt(3)
    v_mfma_f32_16x16x32_bf16 v[56:59], v[80:83], v[32:35], v[48:51]
    s_waitcnt lgkmcnt(2)
    v_mfma_f32_16x16x32_bf16 v[56:59], v[84:87], v[36:39], v[56:59]
    s_waitcnt lgkmcnt(1)
    v_mfma_f32_16x16x32_bf16 v[56:59], v[88:91], v[40:43], v[56:59]
    s_waitcnt lgkmcnt(0)
    v_mfma_f32_16x16x32_bf16 v[56:59], v[92:95], v[44:47], v[56:59]
    s_nop 7
    v_max3_f32 v110, v52, v53, v54
    v_max3_f32 v110, v110, v55, v56
    v_max3_f32 v110, v110, v57, v58
    v_max_f32 v110, v110, v59
    v_cmp_lt_f32 vcc, s57, v110
L_stub22:
    s_cbranch_execz L_dry_back
    s_cbranch_vccz L_h_norare0
    v_mov_b32 v111, v110
    s_nop 1
    v_permlane32_swap_b32 v110, v111
    s_nop 1
    v_max_f32 v110, v110, v111
    v_mov_b32 v111, v110
    s_nop 1
    v_permlane16_swap_b32 v110, v111
    s_nop 1
    v_max_f32 v110, v110, v111
    v_max_f32 v110, s56, v110
    v_max_f32 v111, 0, v110
    v_exp_f32 v111, -v111
    v_sub_f32 v52, v52, v110
    v_sub_f32 v53, v53, v110
    v_sub_f32 v54, v54, v110
    v_sub_f32 v55, v55, v110
    v_sub_f32 v56, v56, v110
    v_sub_f32 v57, v57, v110
    v_sub_f32 v58, v58, v110
    v_sub_f32 v59, v59, v110
    v_sub_f32 v48, v48, v110
    v_sub_f32 v49, v49, v110
    v_sub_f32 v50, v50, v110
    v_sub_f32 v51, v51, v110
    v_mul_f32 v96, v111, v96
    v_mul_f32 v97, v111, v97
    v_mul_f32 v98, v111, v98
    v_mul_f32 v99, v111, v99
    v_mul_f32 v0, v111, v0
    v_mul_f32 v1, v111, v1
    v_mul_f32 v2, v111, v2
    v_mul_f32 v3, v111, v3
    v_mul_f32 v4, v111, v4
    v_mul_f32 v5, v111, v5
    v_mul_f32 v6, v111, v6
    v_mul_f32 v7, v111, v7
    v_mul_f32 v8, v111, v8
    v_mul_f32 v9, v111, v9
    v_mul_f32 v10, v111, v10
    v_mul_f32 v11, v111, v11
    v_mul_f32 v12, v111, v12
    v_mul_f32 v13, v111, v13
    v_mul_f32 v14, v111, v14
    v_mul_f32 v15, v111, v15
    v_mul_f32 v16, v111, v16
    v_mul_f32 v17, v111, v17
    v_mul_f32 v18, v111, v18
    v_mul_f32 v19, v111, v19
    v_mul_f32 v20, v111, v20
    v_mul_f32 v21, v111, v21
    v_mul_f32 v22, v111, v22
    v_mul_f32 v23, v111, v23
    v_mul_f32 v24, v111, v24
    v_mul_f32 v25, v111, v25
    v_mul_f32 v26, v111, v26
    v_mul_f32 v27, v111, v27
    v_mul_f32 v28, v111, v28
    v_mul_f32 v29, v111, v29
    v_mul_f32 v30, v111, v30
    v_mul_f32 v31, v111, v31
L_stub23:
    s_cbranch_execz L_dry_back
    s_mov_b32 s56, 0
    s_mov_b32 s57, 0x41000000
L_h_norare0:
    v_exp_f32 v52, v52
    v_exp_f32 v53, v53
    v_exp_f32 v54, v54
    v_exp_f32 v55, v55
    v_exp_f32 v56, v56
    v_exp_f32 v57, v57
    v_exp_f32 v58, v58
    v_exp_f32 v59, v59
    s_nop 0
    v_cvt_pk_bf16_f32 v60, v52, v53
    v_cvt_pk_bf16_f32 v61, v54, v55
    v_cvt_pk_bf16_f32 v62, v56, v57
    v_cvt_pk_bf16_f32 v63, v58, v59
    s_nop 1
L_h_noqk0:
    v_add_u32 v112, 4294830080, v112
    v_add_u32 v113, 4294830080, v113
    v_add_u32 v114, 4294830080, v114
    v_add_u32 v115, 4294830080, v115
    s_branch L_h_body
L_h_loop:
    s_barrier
L_h_body:
    s_mov_b32 s3, 0
    s_cmp_eq_u32 s62, 0
    s_cbranch_scc1 L_h_pv
    s_cmp_eq_u32 s53, 15
    s_cbranch_scc1 L_h_fin
    s_cmp_ge_u32 s53, 14
    s_cbranch_scc1 L_h_noda
    s_sub_u32 s43, s53, 2
    s_cmp_lt_u32 s43, 7
    s_cbranch_scc1 L_h_pia
    s_cmp_eq_u32 s53, 9
    s_cselect_b32 s49, s63, s49
    s_cselect_b32 s47, s48, s47
    s_sub_u32 s43, s53, 9
    s_cmp_lt_u32 s43, 4
    s_cbranch_scc0 L_h_pida
L_h_pia:
    s_and_b32 s43, s43, 3
    s_lshl_b32 s43, s43, 12
    s_add_u32 s43, s43, s46
    s_mul_i32 s52, s49, 40960
    s_add_u32 s52, s52, s47
    s_add_u32 m0, s43, 0
    s_add_u32 s54, s52, 0
    buffer_load_dwordx4 v130, s[20:23], s54 offen lds
    s_add_u32 m0, s43, 1024
    s_add_u32 s54, s52, 10240
    buffer_load_dwordx4 v130, s[20:23], s54 offen lds
L_stub24:
    s_cbranch_execz L_dry_back
    s_add_u32 m0, s43, 2048
    s_add_u32 s54, s52, 20480
    buffer_load_dwordx4 v130, s[20:23], s54 offen lds
    s_add_u32 m0, s43, 3072
    s_add_u32 s54, s52, 30720
    buffer_load_dwordx4 v130, s[20:23], s54 offen lds
    s_add_u32 s49, s49, 1
    s_and_b32 s49, s49, 7
    s_mov_b32 s3, 1
L_h_pida:
    s_cmp_lg_u32 s53, 1
    s_cbranch_scc1 L_h_nova
    buffer_load_dword v131, v133, s[24:27], 0 offen sc1
    buffer_load_dword v131, v133, s[24:27], 0 offen sc1
    buffer_load_dword v131, v133, s[24:27], 0 offen sc1
    buffer_load_dword v131, v133, s[24:27], 0 offen sc1
L_h_vda:
    s_mov_b32 s3, 1
L_h_nova:
    s_cmp_lg_u32 s53, 13
    s_cbranch_scc1 L_h_ka
    s_lshl_b32 s43, s58, 3
    s_add_u32 s43, s43, s40
    s_mul_i32 s47, s43, 327680
    s_lshl_b32 s43, s61, 7
    s_add_u32 s47, s47, s43
    s_add_u32 s49, s63, 7
    s_and_b32 s49, s49, 7
    s_mul_i32 s52, s49, 40960
    s_add_u32 s52, s52, s47
    s_add_u32 m0, s51, 0
    s_add_u32 s54, s52, 0
    buffer_load_dwordx4 v130, s[20:23], s54 offen lds
    s_add_u32 m0, s51, 1024
    s_add_u32 s54, s52, 10240
    buffer_load_dwordx4 v130, s[20:23], s54 offen lds
    s_add_u32 m0, s51, 2048
    s_add_u32 s54, s52, 20480
    buffer_load_dwordx4 v130, s[20:23], s54 offen lds
    s_add_u32 m0, s51, 3072
    s_add_u32 s54, s52, 30720
    buffer_load_dwordx4 v130, s[20:23], s54 offen lds
    s_branch L_h_va
L_h_ka:
    s_mov_b32 m0, s51
L_stub25:
    s_cbranch_execz L_dry_back
    s_nop 0
    buffer_load_dwordx4 v104, s[28:31], 0 offen offset:0 nt lds
    buffer_load_dwordx4 v105, s[28:31], 0 offen offset:1024 nt lds
    buffer_load_dwordx4 v106, s[28:31], 0 offen offset:2048 nt lds
    buffer_load_dwordx4 v107, s[28:31], 0 offen offset:3072 nt lds
    v_add_u32 v104, 16384, v104
    v_add_u32 v105, 16384, v105
    v_add_u32 v106, 16384, v106
    v_add_u32 v107, 16384, v107
L_h_va:
    s_add_u32 m0, s51, 16384
    s_nop 0
    buffer_load_dwordx4 v108, s[32:35], 0 offen offset:0 nt lds
    buffer_load_dwordx4 v109, s[32:35], 0 offen offset:1024 nt lds
    buffer_load_dwordx4 v108, s[32:35], 0 offen offset:2048 nt lds
    buffer_load_dwordx4 v109, s[32:35], 0 offen offset:3072 nt lds
    v_add_u32 v108, 16384, v108
    v_add_u32 v109, 16384, v109
L_h_v2a:
    s_add_u32 s55, s55, 1
    s_mov_b32 s43, 32768
    s_cmp_eq_u32 s55, 3
    s_cselect_b32 s43, 4294901760, s43
    s_cselect_b32 s55, 0, s55
    s_add_u32 s51, s51, s43
L_h_noda:
    ds_read_b128 v[64:67], v112 offset:0
    ds_read_b128 v[68:71], v113 offset:0
    ds_read_b128 v[72:75], v114 offset:0
    ds_read_b128 v[76:79], v115 offset:0
    ds_read_b128 v[80:83], v112 offset:4096
    ds_read_b128 v[84:87], v113 offset:4096
    ds_read_b128 v[88:91], v114 offset:4096
    ds_read_b128 v[92:95], v115 offset:4096
    s_waitcnt lgkmcnt(7)
    v_mfma_f32_16x16x32_bf16 v[52:55], v[64:67], v[32:35], v[48:51]
    s_waitcnt lgkmcnt(6)
    v_mfma_f32_16x16x32_bf16 v[52:55], v[68:71], v[36:39], v[52:55]
    s_waitcnt lgkmcnt(5)
L_stub26:
    s_cbranch_execz L_dry_back
    v_mfma_f32_16x16x32_bf16 v[52:55], v[72:75], v[40:43], v[52:55]
    s_waitcnt lgkmcnt(4)
    v_mfma_f32_16x16x32_bf16 v[52:55], v[76:79], v[44:47], v[52:55]
    s_waitcnt lgkmcnt(3)
    v_mfma_f32_16x16x32_bf16 v[56:59], v[80:83], v[32:35], v[48:51]
    s_waitcnt lgkmcnt(2)
    v_mfma_f32_16x16x32_bf16 v[56:59], v[84:87], v[36:39], v[56:59]
    s_waitcnt lgkmcnt(1)
    v_mfma_f32_16x16x32_bf16 v[56:59], v[88:91], v[40:43], v[56:59]
    s_waitcnt lgkmcnt(0)
    v_mfma_f32_16x16x32_bf16 v[56:59], v[92:95], v[44:47], v[56:59]
    s_nop 7
    v_max3_f32 v110, v52, v53, v54
    v_max3_f32 v110, v110, v55, v56
    v_max3_f32 v110, v110, v57, v58
    v_max_f32 v110, v110, v59
    v_cmp_lt_f32 vcc, s57, v110
    s_cbranch_vccz L_h_norare1
    v_mov_b32 v111, v110
    s_nop 1
    v_permlane32_swap_b32 v110, v111
    s_nop 1
    v_max_f32 v110, v110, v111
    v_mov_b32 v111, v110
    s_nop 1
    v_permlane16_swap_b32 v110, v111
    s_nop 1
    v_max_f32 v110, v110, v111
    v_max_f32 v110, s56, v110
    v_max_f32 v111, 0, v110
    v_exp_f32 v111, -v111
    v_sub_f32 v52, v52, v110
    v_sub_f32 v53, v53, v110
    v_sub_f32 v54, v54, v110
    v_sub_f32 v55, v55, v110
    v_sub_f32 v56, v56, v110
    v_sub_f32 v57, v57, v110
    v_sub_f32 v58, v58, v110
    v_sub_f32 v59, v59, v110
    v_sub_f32 v48, v48, v110
    v_sub_f32 v49, v49, v110
    v_sub_f32 v50, v50, v110
    v_sub_f32 v51, v51, v110
    v_mul_f32 v96, v111, v96
    v_mul_f32 v97, v111, v97
    v_mul_f32 v98, v111, v98
    v_mul_f32 v99, v111, v99
    v_mul_f32 v0, v111, v0
    v_mul_f32 v1, v111, v1
    v_mul_f32 v2, v111, v2
    v_mul_f32 v3, v111, v3
    v_mul_f32 v4, v111, v4
    v_mul_f32 v5, v111, v5
L_stub27:
    s_cbranch_execz L_dry_back
    v_mul_f32 v6, v111, v6
    v_mul_f32 v7, v111, v7
    v_mul_f32 v8, v111, v8
    v_mul_f32 v9, v111, v9
    v_mul_f32 v10, v111, v10
    v_mul_f32 v11, v111, v11
    v_mul_f32 v12, v111, v12
    v_mul_f32 v13, v111, v13
    v_mul_f32 v14, v111, v14
    v_mul_f32 v15, v111, v15
    v_mul_f32 v16, v111, v16
    v_mul_f32 v17, v111, v17
    v_mul_f32 v18, v111, v18
    v_mul_f32 v19, v111, v19
    v_mul_f32 v20, v111, v20
    v_mul_f32 v21, v111, v21
    v_mul_f32 v22, v111, v22
    v_mul_f32 v23, v111, v23
    v_mul_f32 v24, v111, v24
    v_mul_f32 v25, v111, v25
    v_mul_f32 v26, v111, v26
    v_mul_f32 v27, v111, v27
    v_mul_f32 v28, v111, v28
    v_mul_f32 v29, v111, v29
    v_mul_f32 v30, v111, v30
    v_mul_f32 v31, v111, v31
    s_mov_b32 s56, 0
    s_mov_b32 s57, 0x41000000
L_h_norare1:
    v_exp_f32 v52, v52
    v_exp_f32 v53, v53
    v_exp_f32 v54, v54
    v_exp_f32 v55, v55
    v_exp_f32 v56, v56
    v_exp_f32 v57, v57
    v_exp_f32 v58, v58
    v_exp_f32 v59, v59
    s_nop 0
    v_cvt_pk_bf16_f32 v60, v52, v53
    v_cvt_pk_bf16_f32 v61, v54, v55
    v_cvt_pk_bf16_f32 v62, v56, v57
    v_cvt_pk_bf16_f32 v63, v58, v59
    s_nop 1
    s_branch L_h_cdone
L_h_pv:
    ds_read_b64_tr_b16 v[64:65], v116 offset:0
    ds_read_b64_tr_b16 v[66:67], v116 offset:4096
    ds_read_b64_tr_b16 v[68:69], v117 offset:0
    ds_read_b64_tr_b16 v[70:71], v117 offset:4096
    ds_read_b64_tr_b16 v[72:73], v118 offset:0
    ds_read_b64_tr_b16 v[74:75], v118 offset:4096
    ds_read_b64_tr_b16 v[76:77], v119 offset:0
    ds_read_b64_tr_b16 v[78:79], v119 offset:4096
L_stub28:
    s_cbranch_execz L_dry_back
    ds_read_b64_tr_b16 v[80:81], v120 offset:0
    ds_read_b64_tr_b16 v[82:83], v120 offset:4096
    ds_read_b64_tr_b16 v[84:85], v121 offset:0
    ds_read_b64_tr_b16 v[86:87], v121 offset:4096
    v_mfma_f32_16x16x32_bf16 v[96:99], v[100:103], v[60:63], v[96:99]
    s_waitcnt lgkmcnt(10)
    v_mfma_f32_16x16x32_bf16 v[0:3], v[64:67], v[60:63], v[0:3]
    ds_read_b64_tr_b16 v[88:89], v122 offset:0
    ds_read_b64_tr_b16 v[90:91], v122 offset:4096
    s_waitcnt lgkmcnt(10)
    v_mfma_f32_16x16x32_bf16 v[4:7], v[68:71], v[60:63], v[4:7]
    ds_read_b64_tr_b16 v[92:93], v123 offset:0
    ds_read_b64_tr_b16 v[94:95], v123 offset:4096
    s_waitcnt lgkmcnt(10)
    v_mfma_f32_16x16x32_bf16 v[8:11], v[72:75], v[60:63], v[8:11]
    s_waitcnt lgkmcnt(8)
    v_mfma_f32_16x16x32_bf16 v[12:15], v[76:79], v[60:63], v[12:15]
    s_waitcnt lgkmcnt(6)
    v_mfma_f32_16x16x32_bf16 v[16:19], v[80:83], v[60:63], v[16:19]
    s_waitcnt lgkmcnt(4)
    v_mfma_f32_16x16x32_bf16 v[20:23], v[84:87], v[60:63], v[20:23]
    s_waitcnt lgkmcnt(2)
    v_mfma_f32_16x16x32_bf16 v[24:27], v[88:91], v[60:63], v[24:27]
    s_waitcnt lgkmcnt(0)
    v_mfma_f32_16x16x32_bf16 v[28:31], v[92:95], v[60:63], v[28:31]
    s_cmp_eq_u32 s53, 15
    s_cbranch_scc1 L_h_fin
    s_cmp_ge_u32 s53, 14
    s_cbranch_scc1 L_h_nodb
    s_sub_u32 s43, s53, 2
    s_cmp_lt_u32 s43, 7
    s_cbranch_scc1 L_h_pib
    s_cmp_eq_u32 s53, 9
    s_cselect_b32 s49, s63, s49
    s_cselect_b32 s47, s48, s47
    s_sub_u32 s43, s53, 9
    s_cmp_lt_u32 s43, 4
    s_cbranch_scc0 L_h_pidb
L_h_pib:
    s_and_b32 s43, s43, 3
    s_lshl_b32 s43, s43, 12
    s_add_u32 s43, s43, s46
    s_mul_i32 s52, s49, 40960
    s_add_u32 s52, s52, s47
    s_add_u32 m0, s43, 0
L_stub29:
    s_cbranch_execz L_dry_back
    s_add_u32 s54, s52, 0
    buffer_load_dwordx4 v130, s[20:23], s54 offen lds
    s_add_u32 m0, s43, 1024
    s_add_u32 s54, s52, 10240
    buffer_load_dwordx4 v130, s[20:23], s54 offen lds
    s_add_u32 m0, s43, 2048
    s_add_u32 s54, s52, 20480
    buffer_load_dwordx4 v130, s[20:23], s54 offen lds
    s_add_u32 m0, s43, 3072
    s_add_u32 s54, s52, 30720
    buffer_load_dwordx4 v130, s[20:23], s54 offen lds
    s_add_u32 s49, s49, 1
    s_and_b32 s49, s49, 7
    s_mov_b32 s3, 1
L_h_pidb:
    s_cmp_lg_u32 s53, 1
    s_cbranch_scc1 L_h_novb
    buffer_load_dword v131, v133, s[24:27], 0 offen sc1
    buffer_load_dword v131, v133, s[24:27], 0 offen sc1
    buffer_load_dword v131, v133, s[24:27], 0 offen sc1
    buffer_load_dword v131, v133, s[24:27], 0 offen sc1
L_h_vdb:
    s_mov_b32 s3, 1
L_h_novb:
    s_cmp_lg_u32 s53, 13
    s_cbranch_scc1 L_h_kb
    s_lshl_b32 s43, s58, 3
    s_add_u32 s43, s43, s40
    s_mul_i32 s47, s43, 327680
    s_lshl_b32 s43, s61, 7
    s_add_u32 s47, s47, s43
    s_add_u32 s49, s63, 7
    s_and_b32 s49, s49, 7
    s_mul_i32 s52, s49, 40960
    s_add_u32 s52, s52, s47
    s_add_u32 m0, s51, 0
    s_add_u32 s54, s52, 0
    buffer_load_dwordx4 v130, s[20:23], s54 offen lds
    s_add_u32 m0, s51, 1024
    s_add_u32 s54, s52, 10240
    buffer_load_dwordx4 v130, s[20:23], s54 offen lds
    s_add_u32 m0, s51, 2048
    s_add_u32 s54, s52, 20480
    buffer_load_dwordx4 v130, s[20:23], s54 offen lds
L_stub30:
    s_cbranch_execz L_dry_back
    s_add_u32 m0, s51, 3072
    s_add_u32 s54, s52, 30720
    buffer_load_dwordx4 v130, s[20:23], s54 offen lds
    s_branch L_h_vb
L_h_kb:
    s_mov_b32 m0, s51
    s_nop 0
    buffer_load_dwordx4 v104, s[28:31], 0 offen offset:0 nt lds
    buffer_load_dwordx4 v105, s[28:31], 0 offen offset:1024 nt lds
    buffer_load_dwordx4 v106, s[28:31], 0 offen offset:2048 nt lds
    buffer_load_dwordx4 v107, s[28:31], 0 offen offset:3072 nt lds
    v_add_u32 v104, 16384, v104
    v_add_u32 v105, 16384, v105
    v_add_u32 v106, 16384, v106
    v_add_u32 v107, 16384, v107
L_h_vb:
    s_add_u32 m0, s51, 16384
    s_nop 0
    buffer_load_dwordx4 v108, s[32:35], 0 offen offset:0 nt lds
    buffer_load_dwordx4 v109, s[32:35], 0 offen offset:1024 nt lds
    buffer_load_dwordx4 v108, s[32:35], 0 offen offset:2048 nt lds
    buffer_load_dwordx4 v109, s[32:35], 0 offen offset:3072 nt lds
    v_add_u32 v108, 16384, v108
    v_add_u32 v109, 16384, v109
L_h_v2b:
    s_add_u32 s55, s55, 1
    s_mov_b32 s43, 32768
    s_cmp_eq_u32 s55, 3
    s_cselect_b32 s43, 4294901760, s43
    s_cselect_b32 s55, 0, s55
    s_add_u32 s51, s51, s43
L_h_nodb:
L_h_cdone:
    s_xor_b32 s62, s62, 1
    s_add_u32 s45, s45, 1
    s_mov_b32 s44, 32768
    s_cmp_eq_u32 s45, 3
    s_cselect_b32 s44, 4294901760, s44
    s_cselect_b32 s45, 0, s45
    v_add_u32 v112, s44, v112
    v_add_u32 v113, s44, v113
    v_add_u32 v114, s44, v114
    v_add_u32 v115, s44, v115
    v_add_u32 v116, s44, v116
    v_add_u32 v117, s44, v117
L_stub31:
    s_cbranch_execz L_dry_back
    v_add_u32 v118, s44, v118
    v_add_u32 v119, s44, v119
    v_add_u32 v120, s44, v120
    v_add_u32 v121, s44, v121
    v_add_u32 v122, s44, v122
    v_add_u32 v123, s44, v123
    s_cmp_lg_u32 s53, 4
    s_cbranch_scc1 L_h_pr0
    ds_read_b64_tr_b16 v[136:137], v126 offset:0
    ds_read_b64_tr_b16 v[138:139], v126 offset:2048
    ds_read_b64_tr_b16 v[140:141], v127 offset:0
    ds_read_b64_tr_b16 v[142:143], v127 offset:2048
    ds_read_b64_tr_b16 v[144:145], v128 offset:0
    ds_read_b64_tr_b16 v[146:147], v128 offset:2048
    ds_read_b64_tr_b16 v[148:149], v129 offset:0
    ds_read_b64_tr_b16 v[150:151], v129 offset:2048
    s_branch L_h_prd
L_h_pr0:
    s_cmp_lg_u32 s53, 5
    s_cbranch_scc1 L_h_pr1
    ds_read_b64_tr_b16 v[152:153], v126 offset:4096
    ds_read_b64_tr_b16 v[154:155], v126 offset:6144
    ds_read_b64_tr_b16 v[156:157], v127 offset:4096
    ds_read_b64_tr_b16 v[158:159], v127 offset:6144
    ds_read_b64_tr_b16 v[160:161], v128 offset:4096
    ds_read_b64_tr_b16 v[162:163], v128 offset:6144
    ds_read_b64_tr_b16 v[164:165], v129 offset:4096
    ds_read_b64_tr_b16 v[166:167], v129 offset:6144
    s_branch L_h_prd
L_h_pr1:
    s_cmp_lg_u32 s53, 6
    s_cbranch_scc1 L_h_pr2
    ds_read_b64_tr_b16 v[168:169], v126 offset:8192
    ds_read_b64_tr_b16 v[170:171], v126 offset:10240
    ds_read_b64_tr_b16 v[172:173], v127 offset:8192
    ds_read_b64_tr_b16 v[174:175], v127 offset:10240
    ds_read_b64_tr_b16 v[176:177], v128 offset:8192
    ds_read_b64_tr_b16 v[178:179], v128 offset:10240
    ds_read_b64_tr_b16 v[180:181], v129 offset:8192
    ds_read_b64_tr_b16 v[182:183], v129 offset:10240
    s_branch L_h_prd
L_h_pr2:
L_stub32:
    s_cbranch_execz L_dry_back
    s_cmp_lg_u32 s53, 7
    s_cbranch_scc1 L_h_pr3
    ds_read_b64_tr_b16 v[184:185], v126 offset:12288
    ds_read_b64_tr_b16 v[186:187], v126 offset:14336
    ds_read_b64_tr_b16 v[188:189], v127 offset:12288
    ds_read_b64_tr_b16 v[190:191], v127 offset:14336
    ds_read_b64_tr_b16 v[192:193], v128 offset:12288
    ds_read_b64_tr_b16 v[194:195], v128 offset:14336
    ds_read_b64_tr_b16 v[196:197], v129 offset:12288
    ds_read_b64_tr_b16 v[198:199], v129 offset:14336
    s_branch L_h_prd
L_h_pr3:
    s_cmp_lg_u32 s53, 8
    s_cbranch_scc1 L_h_pr4
    ds_read_b64_tr_b16 v[200:201], v126 offset:0
    ds_read_b64_tr_b16 v[202:203], v126 offset:2048
    ds_read_b64_tr_b16 v[204:205], v127 offset:0
    ds_read_b64_tr_b16 v[206:207], v127 offset:2048
    ds_read_b64_tr_b16 v[208:209], v128 offset:0
    ds_read_b64_tr_b16 v[210:211], v128 offset:2048
    ds_read_b64_tr_b16 v[212:213], v129 offset:0
    ds_read_b64_tr_b16 v[214:215], v129 offset:2048
    s_branch L_h_prd
L_h_pr4:
    s_cmp_lg_u32 s53, 9
    s_cbranch_scc1 L_h_pr5
    ds_read_b64_tr_b16 v[216:217], v126 offset:4096
    ds_read_b64_tr_b16 v[218:219], v126 offset:6144
    ds_read_b64_tr_b16 v[220:221], v127 offset:4096
    ds_read_b64_tr_b16 v[222:223], v127 offset:6144
    ds_read_b64_tr_b16 v[224:225], v128 offset:4096
    ds_read_b64_tr_b16 v[226:227], v128 offset:6144
    ds_read_b64_tr_b16 v[228:229], v129 offset:4096
    ds_read_b64_tr_b16 v[230:231], v129 offset:6144
    s_branch L_h_prd
L_h_pr5:
    s_cmp_lg_u32 s53, 10
    s_cbranch_scc1 L_h_pr6
    ds_read_b64_tr_b16 v[232:233], v126 offset:8192
    ds_read_b64_tr_b16 v[234:235], v126 offset:10240
L_stub33:
    s_cbranch_execz L_dry_back
    ds_read_b64_tr_b16 v[236:237], v127 offset:8192
    ds_read_b64_tr_b16 v[238:239], v127 offset:10240
    ds_read_b64_tr_b16 v[240:241], v128 offset:8192
    ds_read_b64_tr_b16 v[242:243], v128 offset:10240
    ds_read_b64_tr_b16 v[244:245], v129 offset:8192
    ds_read_b64_tr_b16 v[246:247], v129 offset:10240
    s_branch L_h_prd
L_h_pr6:
L_h_prd:
    s_cmp_eq_u32 s3, 2
    s_cbranch_scc1 L_h_w16
    s_cmp_eq_u32 s3, 1
    s_cbranch_scc1 L_h_w12
    s_cmp_eq_u32 s53, 14
    s_cbranch_scc0 L_h_w8
    s_add_u32 s49, s63, 4
    s_and_b32 s49, s49, 7
    s_mul_i32 s52, s49, 40960
    s_add_u32 s52, s52, s48
    s_add_u32 m0, s50, 32768
    s_add_u32 s54, s52, 0
    buffer_load_dwordx4 v130, s[20:23], s54 offen lds
    s_add_u32 m0, s50, 33792
    s_add_u32 s54, s52, 10240
    buffer_load_dwordx4 v130, s[20:23], s54 offen lds
    s_add_u32 m0, s50, 34816
    s_add_u32 s54, s52, 20480
    buffer_load_dwordx4 v130, s[20:23], s54 offen lds
    s_add_u32 m0, s50, 35840
    s_add_u32 s54, s52, 30720
    buffer_load_dwordx4 v130, s[20:23], s54 offen lds
    s_waitcnt vmcnt(4)
L_h_w8:
    s_waitcnt vmcnt(8)
L_h_w12:
    s_waitcnt vmcnt(12)
L_h_w16:
    s_waitcnt vmcnt(16) lgkmcnt(0)
L_h_wd:
    s_cmp_lg_u32 s53, 14
    s_cbranch_scc1 L_h_vok
    s_mov_b32 s54, 0
L_h_vchk:
    v_cmp_ne_u32 vcc, 1, v131
    s_cbranch_vccz L_h_vok
    s_sleep 8
    buffer_load_dword v131, v133, s[24:27], 0 offen sc1
    s_add_u32 s54, s54, 1
    s_waitcnt vmcnt(0)
    s_cmp_lt_u32 s54, 0x40000
L_stub34:
    s_cbranch_execz L_dry_back
    s_cbranch_scc1 L_h_vchk
L_h_vok:
    s_add_u32 s53, s53, 1
    s_branch L_h_loop
L_h_fin:
    s_nop 7
    s_mul_i32 s43, s59, 2560
    s_add_u32 s43, s43, 49152
    v_lshlrev_b32 v124, 4, v255
    v_add_u32 v124, s43, v124
    v_lshlrev_b32 v125, 3, v255
    v_add_u32 v125, s43, v125
    v_mov_b32 v49, v96
    ds_write_b128 v124, v[0:3] offset:0
    ds_write_b128 v124, v[4:7] offset:1024
    ds_write_b64 v125, v[48:49] offset:2048
    ds_write_b128 v124, v[8:11] offset:12288
    ds_write_b128 v124, v[12:15] offset:13312
    ds_write_b64 v125, v[48:49] offset:14336
    ds_write_b128 v124, v[16:19] offset:24576
    ds_write_b128 v124, v[20:23] offset:25600
    ds_write_b64 v125, v[48:49] offset:26624
    ds_write_b128 v124, v[24:27] offset:36864
    ds_write_b128 v124, v[28:31] offset:37888
    ds_write_b64 v125, v[48:49] offset:38912
    s_mov_b32 s36, s18
    s_mov_b32 s37, s19
    s_mov_b32 s38, 16777216
    s_mov_b32 s39, 0x20000
    s_waitcnt lgkmcnt(0) vmcnt(0)
    s_barrier
    s_sub_u32 s43, s50, s46
    v_add_u32 v126, s43, v126
    v_add_u32 v127, s43, v127
    v_add_u32 v128, s43, v128
    v_add_u32 v129, s43, v129
    ds_read_b64_tr_b16 v[108:109], v126 offset:0
    ds_read_b64_tr_b16 v[110:111], v126 offset:2048
    ds_read_b64_tr_b16 v[112:113], v127 offset:0
    ds_read_b64_tr_b16 v[114:115], v127 offset:2048
    ds_read_b64_tr_b16 v[116:117], v128 offset:0
    ds_read_b64_tr_b16 v[118:119], v128 offset:2048
    ds_read_b64_tr_b16 v[120:121], v129 offset:0
L_stub35:
    s_cbranch_execz L_dry_back
    ds_read_b64_tr_b16 v[122:123], v129 offset:2048
    s_waitcnt lgkmcnt(0)
    s_barrier
    s_branch L_tail_h
L_dry:
    s_mov_b64 exec, 0
    s_lshr_b32 s57, s2, 3
    s_mul_i32 s57, s57, 1
    s_mov_b32 s58, 0
L_dry_next:
    s_mul_i32 s63, s57, 3856
    s_lshr_b32 s63, s63, 16
    s_mul_i32 s63, s63, 17
    s_sub_u32 s63, s57, s63
    s_mul_i32 s52, s56, 17
    s_add_u32 s63, s63, s52
    s_cmp_ge_u32 s63, 102
    s_cbranch_scc1 L_dry_back
    s_lshl_b32 s63, s63, 2
    s_getpc_b64 s[60:61]
L_dry_pc:
    s_add_u32 s60, s60, s63
    s_addc_u32 s61, s61, 0
    s_add_u32 s60, s60, L_dry_tab-L_dry_pc
    s_addc_u32 s61, s61, 0
    s_setpc_b64 s[60:61]
L_dry_tab:
    s_branch L_stub0
    s_branch L_stub1
    s_branch L_stub2
    s_branch L_stub3
    s_branch L_stub4
    s_branch L_stub5
    s_branch L_stub6
    s_branch L_stub7
    s_branch L_stub8
    s_branch L_stub9
    s_branch L_stub10
    s_branch L_stub11
    s_branch L_stub12
    s_branch L_stub13
    s_branch L_stub14
    s_branch L_stub15
    s_branch L_stub16
    s_branch L_stub17
    s_branch L_stub18
    s_branch L_stub19
    s_branch L_stub20
    s_branch L_stub21
    s_branch L_stub22
    s_branch L_stub23
    s_branch L_stub24
    s_branch L_stub25
    s_branch L_stub26
    s_branch L_stub27
    s_branch L_stub28
    s_branch L_stub29
    s_branch L_stub30
    s_branch L_stub31
    s_branch L_stub32
    s_branch L_stub33
    s_branch L_stub34
    s_branch L_stub35
    s_branch L_stub36
    s_branch L_stub37
    s_branch L_stub38
    s_branch L_stub39
    s_branch L_stub40
    s_branch L_stub41
    s_branch L_stub42
    s_branch L_stub43
    s_branch L_stub44
    s_branch L_stub45
    s_branch L_stub46
    s_branch L_stub47
    s_branch L_stub48
    s_branch L_stub49
    s_branch L_stub50
    s_branch L_stub51
    s_branch L_stub52
    s_branch L_stub53
    s_branch L_stub54
    s_branch L_stub55
    s_branch L_stub56
    s_branch L_stub57
    s_branch L_stub58
    s_branch L_stub59
    s_branch L_stub60
    s_branch L_stub61
    s_branch L_stub62
    s_branch L_stub63
    s_branch L_stub64
    s_branch L_stub65
    s_branch L_stub66
    s_branch L_stub67
    s_branch L_stub68
    s_branch L_stub69
    s_branch L_stub70
    s_branch L_stub71
    s_branch L_stub72
    s_branch L_stub73
    s_branch L_stub74
    s_branch L_stub75
    s_branch L_stub76
    s_branch L_stub77
    s_branch L_stub78
    s_branch L_stub79
    s_branch L_stub80
    s_branch L_stub81
    s_branch L_stub82
    s_branch L_stub83
    s_branch L_stub84
    s_branch L_stub85
    s_branch L_stub86
    s_branch L_stub87
    s_branch L_stub88
    s_branch L_stub89
    s_branch L_stub90
    s_branch L_stub91
    s_branch L_stub92
    s_branch L_stub93
    s_branch L_stub94
    s_branch L_stub95
    s_branch L_stub96
    s_branch L_stub97
    s_branch L_stub98
    s_branch L_stub99
    s_branch L_stub100
    s_branch L_stub100
L_dry_back:
    s_add_u32 s57, s57, 1
    s_add_u32 s58, s58, 1
    s_cmp_lt_u32 s58, 1
    s_cbranch_scc1 L_dry_next
    s_mov_b64 exec, -1
    s_cmp_lt_u32 s40, 4
    s_cbranch_scc1 L_dry_ret_m
    s_branch L_dry_ret_h
L_main:
L_dry_ret_m:
    v_bfe_u32 v184, v255, 2, 2
    v_and_b32 v185, 3, v255
    v_bfe_u32 v186, v255, 4, 1
    v_lshrrev_b32 v188, 4, v255
    v_lshl_add_u32 v190, v186, 2, v184
    v_lshrrev_b32 v191, 1, v185
    v_lshl_add_u32 v190, v190, 1, v191
    v_and_b32 v191, 1, v185
    v_lshlrev_b32 v191, 3, v191
    v_lshl_add_u32 v189, v188, 3, v184
    v_lshl_add_u32 v189, v189, 8, v191
    v_add_u32 v189, 120832, v189
    v_lshl_add_u32 v192, v188, 2, v184
    v_lshl_add_u32 v192, v192, 8, v191
    v_add_u32 v192, 16384, v192
    s_and_b32 s43, s40, 1
    s_lshl_b32 s43, s43, 1
    s_lshr_b32 s44, s40, 1
    s_or_b32 s51, s43, s44
    s_lshl_b32 s43, s51, 2
    v_xor_b32 v191, 0, v190
    v_lshl_add_u32 v224, v191, 4, v192
    v_xor_b32 v191, s43, v191
    v_lshl_add_u32 v240, v191, 4, v189
    v_xor_b32 v191, 2, v190
    v_lshl_add_u32 v225, v191, 4, v192
    v_xor_b32 v191, s43, v191
    v_lshl_add_u32 v241, v191, 4, v189
    v_xor_b32 v191, 4, v190
    v_lshl_add_u32 v226, v191, 4, v192
    v_xor_b32 v191, s43, v191
    v_lshl_add_u32 v242, v191, 4, v189
    v_xor_b32 v191, 6, v190
    v_lshl_add_u32 v227, v191, 4, v192
    v_xor_b32 v191, s43, v191
    v_lshl_add_u32 v243, v191, 4, v189
    v_xor_b32 v191, 8, v190
    v_lshl_add_u32 v228, v191, 4, v192
    v_xor_b32 v191, 10, v190
    v_lshl_add_u32 v229, v191, 4, v192
    v_xor_b32 v191, 12, v190
    v_lshl_add_u32 v230, v191, 4, v192
    v_xor_b32 v191, 14, v190
    v_lshl_add_u32 v231, v191, 4, v192
    v_and_b32 v189, 15, v255
    v_lshlrev_b32 v191, 8, v189
    v_add_u32 v191, 137216, v191
    v_xor_b32 v190, v189, v188
    v_xor_b32 v190, s43, v190
    v_xor_b32 v233, 0, v190
    v_lshl_add_u32 v220, v233, 4, v191
    v_xor_b32 v233, 4, v190
    v_lshl_add_u32 v221, v233, 4, v191
    v_xor_b32 v233, 8, v190
    v_lshl_add_u32 v222, v233, 4, v191
    v_xor_b32 v233, 12, v190
    v_lshl_add_u32 v223, v233, 4, v191
    v_lshlrev_b32 v189, 7, v189
    s_lshl_b32 s43, s40, 12
    s_add_u32 s43, s43, 102400
    v_add_u32 v189, s43, v189
    v_bfe_u32 v190, v255, 1, 3
    v_xor_b32 v190, v190, v188
    v_xor_b32 v191, 0, v190
    v_lshl_add_u32 v236, v191, 4, v189
    v_xor_b32 v191, 4, v190
    v_lshl_add_u32 v237, v191, 4, v189
    s_lshl_b32 s43, s40, 12
    s_sub_u32 s43, 16384, s43
    v_add_u32 v238, s43, v236
    v_add_u32 v239, s43, v237
    s_and_b32 s43, s40, 1
    s_lshl_b32 s43, s43, 13
    s_sub_u32 s43, 4096, s43
    v_add_u32 v244, s43, v236
    v_add_u32 v245, s43, v237
    v_mov_b32 v0, 0
    v_mov_b32 v1, 0
    v_mov_b32 v2, 0
    v_mov_b32 v3, 0
    v_mov_b32 v4, 0
    v_mov_b32 v5, 0
    v_mov_b32 v6, 0
    v_mov_b32 v7, 0
    v_mov_b32 v8, 0
    v_mov_b32 v9, 0
    v_mov_b32 v10, 0
    v_mov_b32 v11, 0
    v_mov_b32 v12, 0
    v_mov_b32 v13, 0
    v_mov_b32 v14, 0
    v_mov_b32 v15, 0
    v_mov_b32 v16, 0
    v_mov_b32 v17, 0
    v_mov_b32 v18, 0
    v_mov_b32 v19, 0
    v_mov_b32 v20, 0
    v_mov_b32 v21, 0
    v_mov_b32 v22, 0
    v_mov_b32 v23, 0
    v_mov_b32 v24, 0
    v_mov_b32 v25, 0
    v_mov_b32 v26, 0
    v_mov_b32 v27, 0
    v_mov_b32 v28, 0
    v_mov_b32 v29, 0
    v_mov_b32 v30, 0
    v_mov_b32 v31, 0
    v_mov_b32 v32, 0
    v_mov_b32 v33, 0
    v_mov_b32 v34, 0
    v_mov_b32 v35, 0
    v_mov_b32 v36, 0
    v_mov_b32 v37, 0
    v_mov_b32 v38, 0
    v_mov_b32 v39, 0
    v_mov_b32 v40, 0
    v_mov_b32 v41, 0
    v_mov_b32 v42, 0
    v_mov_b32 v43, 0
    v_mov_b32 v44, 0
    v_mov_b32 v45, 0
    v_mov_b32 v46, 0
    v_mov_b32 v47, 0
    v_mov_b32 v48, 0
    v_mov_b32 v49, 0
    v_mov_b32 v50, 0
    v_mov_b32 v51, 0
    v_mov_b32 v52, 0
    v_mov_b32 v53, 0
    v_mov_b32 v54, 0
    v_mov_b32 v55, 0
    v_mov_b32 v56, 0
    v_mov_b32 v57, 0
    v_mov_b32 v58, 0
    v_mov_b32 v59, 0
    v_mov_b32 v60, 0
    v_mov_b32 v61, 0
    v_mov_b32 v62, 0
    v_mov_b32 v63, 0
    v_mov_b32 v64, 0
    v_mov_b32 v65, 0
    v_mov_b32 v66, 0
    v_mov_b32 v67, 0
    v_mov_b32 v68, 0
    v_mov_b32 v69, 0
    v_mov_b32 v70, 0
    v_mov_b32 v71, 0
    v_mov_b32 v72, 0
    v_mov_b32 v73, 0
    v_mov_b32 v74, 0
    v_mov_b32 v75, 0
    v_mov_b32 v76, 0
    v_mov_b32 v77, 0
    v_mov_b32 v78, 0
    v_mov_b32 v79, 0
    v_mov_b32 v80, 0
    v_mov_b32 v81, 0
    v_mov_b32 v82, 0
    v_mov_b32 v83, 0
    v_mov_b32 v84, 0
    v_mov_b32 v85, 0
    v_mov_b32 v86, 0
    v_mov_b32 v87, 0
    v_mov_b32 v88, 0
    v_mov_b32 v89, 0
    v_mov_b32 v90, 0
    v_mov_b32 v91, 0
    v_mov_b32 v92, 0
    v_mov_b32 v93, 0
    v_mov_b32 v94, 0
    v_mov_b32 v95, 0
    v_mov_b32 v96, 0
    v_mov_b32 v97, 0
    v_mov_b32 v98, 0
    v_mov_b32 v99, 0
    v_mov_b32 v100, 0
    v_mov_b32 v101, 0
    v_mov_b32 v102, 0
    v_mov_b32 v103, 0
    v_mov_b32 v104, 0
    v_mov_b32 v105, 0
    v_mov_b32 v106, 0
    v_mov_b32 v107, 0
    v_mov_b32 v108, 0
    v_mov_b32 v109, 0
    v_mov_b32 v110, 0
    v_mov_b32 v111, 0
    v_mov_b32 v112, 0
    v_mov_b32 v113, 0
    v_mov_b32 v114, 0
    v_mov_b32 v115, 0
    v_mov_b32 v116, 0
    v_mov_b32 v117, 0
    v_mov_b32 v118, 0
    v_mov_b32 v119, 0
    v_mov_b32 v120, 0
    v_mov_b32 v121, 0
    v_mov_b32 v122, 0
    v_mov_b32 v123, 0
    v_mov_b32 v124, 0
    v_mov_b32 v125, 0
    v_mov_b32 v126, 0
    v_mov_b32 v127, 0
    v_mov_b32 v144, 0
    v_mov_b32 v145, 0
    v_mov_b32 v146, 0
    v_mov_b32 v147, 0
    v_mov_b32 v148, 0
    v_mov_b32 v149, 0
    v_mov_b32 v150, 0
    v_mov_b32 v151, 0
    s_mov_b32 s53, 0
    s_mov_b32 s54, 2
    s_waitcnt lgkmcnt(0)
    s_barrier
    ds_read_b64_tr_b16 v[184:185], v240 offset:0
    ds_read_b64_tr_b16 v[186:187], v240 offset:1024
    ds_read_b128 v[152:155], v236 offset:0
    ds_read_b128 v[156:159], v236 offset:2048
    ds_read_b128 v[160:163], v244 offset:0
    ds_read_b128 v[164:167], v244 offset:2048
    ds_read_b128 v[168:171], v238
    ds_read_b64_tr_b16 v[188:189], v241 offset:0
    ds_read_b64_tr_b16 v[190:191], v241 offset:1024
    ds_read_b64_tr_b16 v[192:193], v242 offset:0
    ds_read_b64_tr_b16 v[194:195], v242 offset:1024
    ds_read_b64_tr_b16 v[196:197], v243 offset:0
    ds_read_b64_tr_b16 v[198:199], v243 offset:1024
L_m_q:
L_stub36:
    s_cbranch_execz L_dry_back
    s_add_u32 s54, s54, 1
    s_mov_b32 s55, 34816
    s_cmp_eq_u32 s54, 3
    s_cselect_b32 s55, 4294897664, s55
    s_cselect_b32 s54, 0, s54
    s_add_u32 s53, s53, 1
    s_waitcnt lgkmcnt(0)
    v_mfma_f32_16x16x32_bf16 v[64:67], v[184:187], v[152:155], v[64:67]
    ds_read_b64_tr_b16 v[200:201], v240 offset:8192
    v_mfma_f32_16x16x32_bf16 v[96:99], v[184:187], v[156:159], v[96:99]
    ds_read_b64_tr_b16 v[202:203], v240 offset:9216
    v_mfma_f32_16x16x32_bf16 v[80:83], v[184:187], v[160:163], v[80:83]
    ds_read_b128 v[128:131], v237 offset:0
    v_mfma_f32_16x16x32_bf16 v[112:115], v[184:187], v[164:167], v[112:115]
    ds_read_b128 v[132:135], v237 offset:2048
    v_mfma_f32_16x16x32_bf16 v[144:147], v[184:187], v[168:171], v[144:147]
    ds_read_b128 v[136:139], v245 offset:0
    v_mfma_f32_16x16x32_bf16 v[68:71], v[188:191], v[152:155], v[68:71]
    ds_read_b128 v[140:143], v245 offset:2048
L_stub37:
    s_cbranch_execz L_dry_back
    v_mfma_f32_16x16x32_bf16 v[100:103], v[188:191], v[156:159], v[100:103]
    ds_read_b128 v[216:219], v239
    v_mfma_f32_16x16x32_bf16 v[84:87], v[188:191], v[160:163], v[84:87]
    ds_read_b64_tr_b16 v[204:205], v241 offset:8192
    v_mfma_f32_16x16x32_bf16 v[116:119], v[188:191], v[164:167], v[116:119]
    ds_read_b64_tr_b16 v[206:207], v241 offset:9216
    v_mfma_f32_16x16x32_bf16 v[148:151], v[188:191], v[168:171], v[148:151]
    ds_read_b64_tr_b16 v[208:209], v242 offset:8192
    v_mfma_f32_16x16x32_bf16 v[72:75], v[192:195], v[152:155], v[72:75]
    ds_read_b64_tr_b16 v[210:211], v242 offset:9216
    v_mfma_f32_16x16x32_bf16 v[104:107], v[192:195], v[156:159], v[104:107]
    ds_read_b64_tr_b16 v[212:213], v243 offset:8192
    v_mfma_f32_16x16x32_bf16 v[88:91], v[192:195], v[160:163], v[88:91]
    ds_read_b64_tr_b16 v[214:215], v243 offset:9216
    v_mfma_f32_16x16x32_bf16 v[120:123], v[192:195], v[164:167], v[120:123]
    v_add_u32 v236, s55, v236
    v_add_u32 v237, s55, v237
    v_mfma_f32_16x16x32_bf16 v[76:79], v[196:199], v[152:155], v[76:79]
    v_add_u32 v238, s55, v238
    v_add_u32 v239, s55, v239
    v_mfma_f32_16x16x32_bf16 v[108:111], v[196:199], v[156:159], v[108:111]
    v_add_u32 v244, s55, v244
    v_add_u32 v245, s55, v245
    v_mfma_f32_16x16x32_bf16 v[92:95], v[196:199], v[160:163], v[92:95]
    v_add_u32 v240, s55, v240
    v_add_u32 v241, s55, v241
    v_mfma_f32_16x16x32_bf16 v[124:127], v[196:199], v[164:167], v[124:127]
    v_add_u32 v242, s55, v242
    v_add_u32 v243, s55, v243
    s_cmp_eq_u32 s53, 10
    s_waitcnt lgkmcnt(0)
    v_mfma_f32_16x16x32_bf16 v[64:67], v[200:203], v[128:131], v[64:67]
    s_barrier
    s_cbranch_scc1 L_m_qdone
    v_mfma_f32_16x16x32_bf16 v[96:99], v[200:203], v[132:135], v[96:99]
    ds_read_b64_tr_b16 v[184:185], v240 offset:0
    v_mfma_f32_16x16x32_bf16 v[80:83], v[200:203], v[136:139], v[80:83]
    ds_read_b64_tr_b16 v[186:187], v240 offset:1024
    v_mfma_f32_16x16x32_bf16 v[112:115], v[200:203], v[140:143], v[112:115]
L_stub38:
    s_cbranch_execz L_dry_back
    ds_read_b128 v[152:155], v236 offset:0
    v_mfma_f32_16x16x32_bf16 v[144:147], v[200:203], v[216:219], v[144:147]
    ds_read_b128 v[156:159], v236 offset:2048
    v_mfma_f32_16x16x32_bf16 v[68:71], v[204:207], v[128:131], v[68:71]
    ds_read_b128 v[160:163], v244 offset:0
    v_mfma_f32_16x16x32_bf16 v[100:103], v[204:207], v[132:135], v[100:103]
    ds_read_b128 v[164:167], v244 offset:2048
    v_mfma_f32_16x16x32_bf16 v[84:87], v[204:207], v[136:139], v[84:87]
    ds_read_b128 v[168:171], v238
    v_mfma_f32_16x16x32_bf16 v[116:119], v[204:207], v[140:143], v[116:119]
    ds_read_b64_tr_b16 v[188:189], v241 offset:0
    v_mfma_f32_16x16x32_bf16 v[148:151], v[204:207], v[216:219], v[148:151]
    ds_read_b64_tr_b16 v[190:191], v241 offset:1024
    v_mfma_f32_16x16x32_bf16 v[72:75], v[208:211], v[128:131], v[72:75]
    ds_read_b64_tr_b16 v[192:193], v242 offset:0
    v_mfma_f32_16x16x32_bf16 v[104:107], v[208:211], v[132:135], v[104:107]
    ds_read_b64_tr_b16 v[194:195], v242 offset:1024
    v_mfma_f32_16x16x32_bf16 v[88:91], v[208:211], v[136:139], v[88:91]
    ds_read_b64_tr_b16 v[196:197], v243 offset:0
    v_mfma_f32_16x16x32_bf16 v[120:123], v[208:211], v[140:143], v[120:123]
    ds_read_b64_tr_b16 v[198:199], v243 offset:1024
    v_mfma_f32_16x16x32_bf16 v[76:79], v[212:215], v[128:131], v[76:79]
    v_mfma_f32_16x16x32_bf16 v[108:111], v[212:215], v[132:135], v[108:111]
    v_mfma_f32_16x16x32_bf16 v[92:95], v[212:215], v[136:139], v[92:95]
    v_mfma_f32_16x16x32_bf16 v[124:127], v[212:215], v[140:143], v[124:127]
    s_branch L_m_q
L_m_qdone:
    v_mfma_f32_16x16x32_bf16 v[96:99], v[200:203], v[132:135], v[96:99]
    ds_read_b128 v[152:155], v220 offset:0
    v_mfma_f32_16x16x32_bf16 v[80:83], v[200:203], v[136:139], v[80:83]
    ds_read_b128 v[156:159], v221 offset:0
    v_mfma_f32_16x16x32_bf16 v[112:115], v[200:203], v[140:143], v[112:115]
    ds_read_b128 v[160:163], v222 offset:0
L_stub39:
    s_cbranch_execz L_dry_back
    v_mfma_f32_16x16x32_bf16 v[144:147], v[200:203], v[216:219], v[144:147]
    ds_read_b128 v[164:167], v223 offset:0
    v_mfma_f32_16x16x32_bf16 v[68:71], v[204:207], v[128:131], v[68:71]
    ds_read_b128 v[168:171], v220 offset:4096
    v_mfma_f32_16x16x32_bf16 v[100:103], v[204:207], v[132:135], v[100:103]
    ds_read_b128 v[172:175], v221 offset:4096
    v_mfma_f32_16x16x32_bf16 v[84:87], v[204:207], v[136:139], v[84:87]
    ds_read_b128 v[176:179], v222 offset:4096
    v_mfma_f32_16x16x32_bf16 v[116:119], v[204:207], v[140:143], v[116:119]
    ds_read_b128 v[180:183], v223 offset:4096
    v_mfma_f32_16x16x32_bf16 v[148:151], v[204:207], v[216:219], v[148:151]
    v_mfma_f32_16x16x32_bf16 v[72:75], v[208:211], v[128:131], v[72:75]
    v_mfma_f32_16x16x32_bf16 v[104:107], v[208:211], v[132:135], v[104:107]
    v_mfma_f32_16x16x32_bf16 v[88:91], v[208:211], v[136:139], v[88:91]
    v_mfma_f32_16x16x32_bf16 v[120:123], v[208:211], v[140:143], v[120:123]
    v_mfma_f32_16x16x32_bf16 v[76:79], v[212:215], v[128:131], v[76:79]
    v_mfma_f32_16x16x32_bf16 v[108:111], v[212:215], v[132:135], v[108:111]
    v_mfma_f32_16x16x32_bf16 v[92:95], v[212:215], v[136:139], v[92:95]
    v_mfma_f32_16x16x32_bf16 v[124:127], v[212:215], v[140:143], v[124:127]
    s_mov_b32 s46, 0x3e0293ee
    s_mov_b32 s47, 0x3e0293ee
    s_mov_b32 s57, 0x41000000
    s_mov_b32 s58, 0x41000000
    s_mov_b32 s53, 0
    s_mov_b32 s45, 0
    v_pk_mul_f32 v[144:145], v[144:145], s[46:47]
    v_pk_mul_f32 v[146:147], v[146:147], s[46:47]
    v_pk_mul_f32 v[148:149], v[148:149], s[46:47]
    v_pk_mul_f32 v[150:151], v[150:151], s[46:47]
    v_cvt_pk_bf16_f32 v144, v144, v145
    v_cvt_pk_bf16_f32 v145, v146, v147
    v_cvt_pk_bf16_f32 v146, v148, v149
L_stub40:
    s_cbranch_execz L_dry_back
    v_cvt_pk_bf16_f32 v147, v150, v151
    s_lshl_b32 s43, s51, 10
    s_add_u32 s43, s43, 153600
    v_lshl_add_u32 v236, v255, 4, s43
    s_lshl_b32 s43, s40, 12
    s_add_u32 s43, s43, 98304
    v_lshl_add_u32 v244, v255, 4, s43
    s_xor_b32 s43, s43, 4096
    v_lshl_add_u32 v245, v255, 4, s43
    v_permlane32_swap_b32 v144, v146
    v_permlane32_swap_b32 v145, v147
    v_pk_mul_f32 v[80:81], v[80:81], s[46:47]
    v_pk_mul_f32 v[82:83], v[82:83], s[46:47]
    v_pk_mul_f32 v[84:85], v[84:85], s[46:47]
    v_pk_mul_f32 v[86:87], v[86:87], s[46:47]
    v_pk_mul_f32 v[88:89], v[88:89], s[46:47]
    v_pk_mul_f32 v[90:91], v[90:91], s[46:47]
    v_pk_mul_f32 v[92:93], v[92:93], s[46:47]
    v_pk_mul_f32 v[94:95], v[94:95], s[46:47]
    v_permlane16_swap_b32 v144, v146
    v_permlane16_swap_b32 v145, v147
    v_cvt_pk_bf16_f32 v184, v80, v81
    v_cvt_pk_bf16_f32 v185, v82, v83
    v_cvt_pk_bf16_f32 v186, v84, v85
    v_cvt_pk_bf16_f32 v187, v86, v87
    v_cvt_pk_bf16_f32 v188, v88, v89
    v_cvt_pk_bf16_f32 v189, v90, v91
    v_cvt_pk_bf16_f32 v190, v92, v93
    v_cvt_pk_bf16_f32 v191, v94, v95
    v_pk_mul_f32 v[112:113], v[112:113], s[46:47]
    v_pk_mul_f32 v[114:115], v[114:115], s[46:47]
    v_pk_mul_f32 v[116:117], v[116:117], s[46:47]
    v_pk_mul_f32 v[118:119], v[118:119], s[46:47]
    v_pk_mul_f32 v[120:121], v[120:121], s[46:47]
    v_pk_mul_f32 v[122:123], v[122:123], s[46:47]
L_stub41:
    s_cbranch_execz L_dry_back
    v_pk_mul_f32 v[124:125], v[124:125], s[46:47]
    v_pk_mul_f32 v[126:127], v[126:127], s[46:47]
    v_cvt_pk_bf16_f32 v192, v112, v113
    v_cvt_pk_bf16_f32 v193, v114, v115
    v_cvt_pk_bf16_f32 v194, v116, v117
    v_cvt_pk_bf16_f32 v195, v118, v119
    v_cvt_pk_bf16_f32 v196, v120, v121
    v_cvt_pk_bf16_f32 v197, v122, v123
    v_cvt_pk_bf16_f32 v198, v124, v125
    v_cvt_pk_bf16_f32 v199, v126, v127
    ds_write_b128 v236, v[144:147]
    v_permlane32_swap_b32 v184, v186
    v_permlane32_swap_b32 v185, v187
    v_permlane32_swap_b32 v188, v190
    v_permlane32_swap_b32 v189, v191
    v_permlane32_swap_b32 v192, v194
    v_permlane32_swap_b32 v193, v195
    v_permlane32_swap_b32 v196, v198
    v_permlane32_swap_b32 v197, v199
    v_permlane16_swap_b32 v184, v186
    v_permlane16_swap_b32 v185, v187
    v_permlane16_swap_b32 v188, v190
    v_permlane16_swap_b32 v189, v191
    v_permlane16_swap_b32 v192, v194
    v_permlane16_swap_b32 v193, v195
    v_permlane16_swap_b32 v196, v198
    v_permlane16_swap_b32 v197, v199
    ds_write_b128 v244, v[184:187] offset:0
    ds_write_b128 v244, v[188:191] offset:1024
    ds_write_b128 v244, v[192:195] offset:2048
    ds_write_b128 v244, v[196:199] offset:3072
    v_pk_mul_f32 v[64:65], v[64:65], s[46:47]
    v_pk_mul_f32 v[66:67], v[66:67], s[46:47]
    v_pk_mul_f32 v[68:69], v[68:69], s[46:47]
    v_pk_mul_f32 v[70:71], v[70:71], s[46:47]
    v_pk_mul_f32 v[72:73], v[72:73], s[46:47]
    v_pk_mul_f32 v[74:75], v[74:75], s[46:47]
    v_pk_mul_f32 v[76:77], v[76:77], s[46:47]
    v_pk_mul_f32 v[78:79], v[78:79], s[46:47]
L_stub42:
    s_cbranch_execz L_dry_back
    v_pk_mul_f32 v[96:97], v[96:97], s[46:47]
    v_pk_mul_f32 v[98:99], v[98:99], s[46:47]
    v_pk_mul_f32 v[100:101], v[100:101], s[46:47]
    v_pk_mul_f32 v[102:103], v[102:103], s[46:47]
    v_pk_mul_f32 v[104:105], v[104:105], s[46:47]
    v_pk_mul_f32 v[106:107], v[106:107], s[46:47]
    v_pk_mul_f32 v[108:109], v[108:109], s[46:47]
    v_pk_mul_f32 v[110:111], v[110:111], s[46:47]
    s_waitcnt lgkmcnt(0)
    s_barrier
    v_cvt_pk_bf16_f32 v64, v64, v65
    v_cvt_pk_bf16_f32 v65, v66, v67
    v_cvt_pk_bf16_f32 v66, v68, v69
    v_cvt_pk_bf16_f32 v67, v70, v71
    v_cvt_pk_bf16_f32 v68, v72, v73
    v_cvt_pk_bf16_f32 v69, v74, v75
    v_cvt_pk_bf16_f32 v70, v76, v77
    v_cvt_pk_bf16_f32 v71, v78, v79
    v_cvt_pk_bf16_f32 v80, v96, v97
    v_cvt_pk_bf16_f32 v81, v98, v99
    v_cvt_pk_bf16_f32 v82, v100, v101
    v_cvt_pk_bf16_f32 v83, v102, v103
    v_cvt_pk_bf16_f32 v84, v104, v105
    v_cvt_pk_bf16_f32 v85, v106, v107
    v_cvt_pk_bf16_f32 v86, v108, v109
    v_cvt_pk_bf16_f32 v87, v110, v111
    ds_read_b128 v[72:75], v245 offset:0
    ds_read_b128 v[76:79], v245 offset:1024
    ds_read_b128 v[88:91], v245 offset:2048
    ds_read_b128 v[92:95], v245 offset:3072
    v_permlane32_swap_b32 v64, v66
    v_permlane32_swap_b32 v65, v67
    v_permlane32_swap_b32 v68, v70
    v_permlane32_swap_b32 v69, v71
    v_permlane32_swap_b32 v80, v82
L_stub43:
    s_cbranch_execz L_dry_back
    v_permlane32_swap_b32 v81, v83
    v_permlane32_swap_b32 v84, v86
    v_permlane32_swap_b32 v85, v87
    v_permlane16_swap_b32 v64, v66
    v_permlane16_swap_b32 v65, v67
    v_permlane16_swap_b32 v68, v70
    v_permlane16_swap_b32 v69, v71
    v_permlane16_swap_b32 v80, v82
    v_permlane16_swap_b32 v81, v83
    v_permlane16_swap_b32 v84, v86
    v_permlane16_swap_b32 v85, v87
    v_mov_b32 v216, 0x3f803f80
    v_mov_b32 v217, 0x3f803f80
    v_mov_b32 v218, 0x3f803f80
    v_mov_b32 v219, 0x3f803f80
    s_waitcnt lgkmcnt(0)
    s_nop 0
    v_mfma_f32_16x16x32_bf16 v[112:115], v[152:155], v[64:67], 0
    v_mfma_f32_16x16x32_bf16 v[120:123], v[152:155], v[80:83], 0
    v_mov_b32 v104, 0
    ds_read_b128 v[152:155], v220 offset:8192
    v_mfma_f32_16x16x32_bf16 v[112:115], v[156:159], v[68:71], v[112:115]
    v_mfma_f32_16x16x32_bf16 v[120:123], v[156:159], v[84:87], v[120:123]
    v_mov_b32 v105, 0
    ds_read_b128 v[156:159], v221 offset:8192
    v_mfma_f32_16x16x32_bf16 v[112:115], v[160:163], v[72:75], v[112:115]
    v_mfma_f32_16x16x32_bf16 v[120:123], v[160:163], v[88:91], v[120:123]
    v_mov_b32 v106, 0
    ds_read_b128 v[160:163], v222 offset:8192
    v_mfma_f32_16x16x32_bf16 v[112:115], v[164:167], v[76:79], v[112:115]
    v_mfma_f32_16x16x32_bf16 v[120:123], v[164:167], v[92:95], v[120:123]
    v_mov_b32 v107, 0
    ds_read_b128 v[164:167], v223 offset:8192
    v_mfma_f32_16x16x32_bf16 v[116:119], v[168:171], v[64:67], 0
    v_mfma_f32_16x16x32_bf16 v[124:127], v[168:171], v[80:83], 0
    v_mov_b32 v108, 0
    ds_read_b128 v[168:171], v220 offset:12288
    v_mfma_f32_16x16x32_bf16 v[116:119], v[172:175], v[68:71], v[116:119]
    v_mfma_f32_16x16x32_bf16 v[124:127], v[172:175], v[84:87], v[124:127]
    v_mov_b32 v109, 0
    ds_read_b128 v[172:175], v221 offset:12288
L_stub44:
    s_cbranch_execz L_dry_back
    v_mfma_f32_16x16x32_bf16 v[116:119], v[176:179], v[72:75], v[116:119]
    v_mfma_f32_16x16x32_bf16 v[124:127], v[176:179], v[88:91], v[124:127]
    v_mov_b32 v110, 0
    ds_read_b128 v[176:179], v222 offset:12288
    v_mfma_f32_16x16x32_bf16 v[116:119], v[180:183], v[76:79], v[116:119]
    v_mfma_f32_16x16x32_bf16 v[124:127], v[180:183], v[92:95], v[124:127]
    v_mov_b32 v111, 0
    ds_read_b128 v[180:183], v223 offset:12288
    v_add_u32 v220, 4294830080, v220
    v_add_u32 v221, 4294830080, v221
    v_add_u32 v222, 4294830080, v222
    v_add_u32 v223, 4294830080, v223
    s_nop 1
    v_max3_f32 v232, v112, v113, v114
    v_max3_f32 v234, v120, v121, v122
    v_max3_f32 v232, v232, v115, v116
    v_max3_f32 v234, v234, v123, v124
    v_max3_f32 v232, v232, v117, v118
    v_max3_f32 v234, v234, v125, v126
    v_max_f32 v232, v232, v119
    v_max_f32 v234, v234, v127
    v_mov_b32 v233, v232
    v_mov_b32 v144, v234
    s_nop 0
    v_permlane32_swap_b32 v232, v233
    v_permlane32_swap_b32 v234, v144
    s_nop 0
    v_max_f32 v232, v232, v233
    v_max_f32 v234, v234, v144
    v_mov_b32 v233, v232
    v_mov_b32 v144, v234
    s_nop 0
    v_permlane16_swap_b32 v232, v233
    v_permlane16_swap_b32 v234, v144
    s_nop 0
    v_max_f32 v232, v232, v233
    v_max_f32 v234, v234, v144
    v_sub_f32 v96, 0, v232
    v_sub_f32 v97, 0, v232
    v_sub_f32 v98, 0, v232
    v_sub_f32 v99, 0, v232
    v_sub_f32 v112, v112, v232
    v_sub_f32 v113, v113, v232
    v_sub_f32 v114, v114, v232
    v_sub_f32 v115, v115, v232
    v_sub_f32 v116, v116, v232
    v_sub_f32 v117, v117, v232
L_stub45:
    s_cbranch_execz L_dry_back
    v_sub_f32 v118, v118, v232
    v_sub_f32 v119, v119, v232
    v_sub_f32 v100, 0, v234
    v_sub_f32 v101, 0, v234
    v_sub_f32 v102, 0, v234
    v_sub_f32 v103, 0, v234
    v_sub_f32 v120, v120, v234
    v_sub_f32 v121, v121, v234
    v_sub_f32 v122, v122, v234
    v_sub_f32 v123, v123, v234
    v_sub_f32 v124, v124, v234
    v_sub_f32 v125, v125, v234
    v_sub_f32 v126, v126, v234
    v_sub_f32 v127, v127, v234
    s_waitcnt lgkmcnt(0)
L_m_loop:
    s_barrier
    v_mfma_f32_16x16x32_bf16 v[128:131], v[152:155], v[64:67], v[96:99]
    v_exp_f32 v112, v112
    v_mfma_f32_16x16x32_bf16 v[136:139], v[152:155], v[80:83], v[100:103]
    v_exp_f32 v113, v113
    ds_read_b64_tr_b16 v[184:185], v224 offset:0
    ds_read_b64_tr_b16 v[186:187], v224 offset:4096
    v_mfma_f32_16x16x32_bf16 v[128:131], v[156:159], v[68:71], v[128:131]
    v_exp_f32 v114, v114
    v_mfma_f32_16x16x32_bf16 v[136:139], v[156:159], v[84:87], v[136:139]
    v_exp_f32 v115, v115
    ds_read_b64_tr_b16 v[188:189], v225 offset:0
    ds_read_b64_tr_b16 v[190:191], v225 offset:4096
    v_mfma_f32_16x16x32_bf16 v[128:131], v[160:163], v[72:75], v[128:131]
    v_exp_f32 v116, v116
    v_mfma_f32_16x16x32_bf16 v[136:139], v[160:163], v[88:91], v[136:139]
    v_exp_f32 v117, v117
    ds_read_b64_tr_b16 v[192:193], v226 offset:0
    ds_read_b64_tr_b16 v[194:195], v226 offset:4096
    v_mfma_f32_16x16x32_bf16 v[128:131], v[164:167], v[76:79], v[128:131]
    v_exp_f32 v118, v118
    v_mfma_f32_16x16x32_bf16 v[136:139], v[164:167], v[92:95], v[136:139]
    v_exp_f32 v119, v119
    ds_read_b64_tr_b16 v[196:197], v227 offset:0
    ds_read_b64_tr_b16 v[198:199], v227 offset:4096
    v_mfma_f32_16x16x32_bf16 v[132:135], v[168:171], v[64:67], v[96:99]
    v_exp_f32 v120, v120
    v_mfma_f32_16x16x32_bf16 v[140:143], v[168:171], v[80:83], v[100:103]
    v_exp_f32 v121, v121
    ds_read_b64_tr_b16 v[200:201], v228 offset:0
L_stub46:
    s_cbranch_execz L_dry_back
    ds_read_b64_tr_b16 v[202:203], v228 offset:4096
    v_mfma_f32_16x16x32_bf16 v[132:135], v[172:175], v[68:71], v[132:135]
    v_exp_f32 v122, v122
    v_cvt_pk_bf16_f32 v144, v112, v113
    v_mfma_f32_16x16x32_bf16 v[140:143], v[172:175], v[84:87], v[140:143]
    v_exp_f32 v123, v123
    v_cvt_pk_bf16_f32 v145, v114, v115
    v_mfma_f32_16x16x32_bf16 v[132:135], v[176:179], v[72:75], v[132:135]
    v_exp_f32 v124, v124
    v_cvt_pk_bf16_f32 v146, v116, v117
    v_mfma_f32_16x16x32_bf16 v[140:143], v[176:179], v[88:91], v[140:143]
    v_exp_f32 v125, v125
    v_cvt_pk_bf16_f32 v147, v118, v119
    v_mfma_f32_16x16x32_bf16 v[132:135], v[180:183], v[76:79], v[132:135]
    v_exp_f32 v126, v126
    v_mfma_f32_16x16x32_bf16 v[140:143], v[180:183], v[92:95], v[140:143]
    v_exp_f32 v127, v127
    v_cvt_pk_bf16_f32 v148, v120, v121
    v_cvt_pk_bf16_f32 v149, v122, v123
    v_cvt_pk_bf16_f32 v150, v124, v125
    v_cvt_pk_bf16_f32 v151, v126, v127
    s_waitcnt lgkmcnt(8)
    v_mfma_f32_16x16x32_bf16 v[0:3], v[184:187], v[144:147], v[0:3]
    ds_read_b64_tr_b16 v[204:205], v229 offset:0
    v_mfma_f32_16x16x32_bf16 v[32:35], v[184:187], v[148:151], v[32:35]
    ds_read_b64_tr_b16 v[206:207], v229 offset:4096
    s_waitcnt lgkmcnt(8)
    v_mfma_f32_16x16x32_bf16 v[4:7], v[188:191], v[144:147], v[4:7]
    ds_read_b64_tr_b16 v[208:209], v230 offset:0
    v_mfma_f32_16x16x32_bf16 v[36:39], v[188:191], v[148:151], v[36:39]
    ds_read_b64_tr_b16 v[210:211], v230 offset:4096
    s_waitcnt lgkmcnt(8)
    v_mfma_f32_16x16x32_bf16 v[8:11], v[192:195], v[144:147], v[8:11]
    ds_read_b64_tr_b16 v[212:213], v231 offset:0
    v_mfma_f32_16x16x32_bf16 v[40:43], v[192:195], v[148:151], v[40:43]
    ds_read_b64_tr_b16 v[214:215], v231 offset:4096
L_stub47:
    s_cbranch_execz L_dry_back
    s_waitcnt lgkmcnt(8)
    v_mfma_f32_16x16x32_bf16 v[12:15], v[196:199], v[144:147], v[12:15]
    ds_read_b128 v[152:155], v220 offset:0
    v_mfma_f32_16x16x32_bf16 v[44:47], v[196:199], v[148:151], v[44:47]
    ds_read_b128 v[156:159], v221 offset:0
    s_waitcnt lgkmcnt(8)
    v_mfma_f32_16x16x32_bf16 v[16:19], v[200:203], v[144:147], v[16:19]
    ds_read_b128 v[160:163], v222 offset:0
    v_max3_f32 v232, v128, v129, v130
    v_mfma_f32_16x16x32_bf16 v[48:51], v[200:203], v[148:151], v[48:51]
    ds_read_b128 v[164:167], v223 offset:0
    v_max3_f32 v232, v232, v131, v132
    s_waitcnt lgkmcnt(8)
    v_mfma_f32_16x16x32_bf16 v[20:23], v[204:207], v[144:147], v[20:23]
    ds_read_b128 v[168:171], v220 offset:4096
    v_max3_f32 v232, v232, v133, v134
    v_mfma_f32_16x16x32_bf16 v[52:55], v[204:207], v[148:151], v[52:55]
    ds_read_b128 v[172:175], v221 offset:4096
    v_max3_f32 v232, v232, v135, v136
    s_waitcnt lgkmcnt(8)
    v_mfma_f32_16x16x32_bf16 v[24:27], v[208:211], v[144:147], v[24:27]
    ds_read_b128 v[176:179], v222 offset:4096
    v_max3_f32 v232, v232, v137, v138
    v_mfma_f32_16x16x32_bf16 v[56:59], v[208:211], v[148:151], v[56:59]
    ds_read_b128 v[180:183], v223 offset:4096
    v_max3_f32 v232, v232, v139, v140
    s_waitcnt lgkmcnt(8)
    v_mfma_f32_16x16x32_bf16 v[28:31], v[212:215], v[144:147], v[28:31]
    v_max3_f32 v232, v232, v141, v142
    v_mfma_f32_16x16x32_bf16 v[60:63], v[212:215], v[148:151], v[60:63]
    v_max_f32 v232, v232, v143
    v_mfma_f32_16x16x32_bf16 v[104:107], v[216:219], v[144:147], v[104:107]
    v_mfma_f32_16x16x32_bf16 v[108:111], v[216:219], v[148:151], v[108:111]
    v_cmp_lt_f32 vcc, s57, v232
    s_cbranch_vccnz L_m_rareB
L_m_retB:
L_stub48:
    s_cbranch_execz L_dry_back
    s_cmp_eq_u32 s53, 15
    s_cbranch_scc1 L_m_last
    s_add_u32 s45, s45, 1
    s_mov_b32 s44, 32768
    s_cmp_eq_u32 s45, 3
    s_cselect_b32 s44, 4294901760, s44
    s_cselect_b32 s45, 0, s45
    s_waitcnt lgkmcnt(7)
    v_mfma_f32_16x16x32_bf16 v[112:115], v[152:155], v[64:67], v[96:99]
    v_exp_f32 v128, v128
    v_mfma_f32_16x16x32_bf16 v[120:123], v[152:155], v[80:83], v[100:103]
    v_exp_f32 v129, v129
    ds_read_b64_tr_b16 v[184:185], v224 offset:8192
    ds_read_b64_tr_b16 v[186:187], v224 offset:12288
    s_waitcnt lgkmcnt(8)
    v_mfma_f32_16x16x32_bf16 v[112:115], v[156:159], v[68:71], v[112:115]
    v_exp_f32 v130, v130
    v_mfma_f32_16x16x32_bf16 v[120:123], v[156:159], v[84:87], v[120:123]
    v_exp_f32 v131, v131
    ds_read_b64_tr_b16 v[188:189], v225 offset:8192
    ds_read_b64_tr_b16 v[190:191], v225 offset:12288
    s_waitcnt lgkmcnt(9)
    v_mfma_f32_16x16x32_bf16 v[112:115], v[160:163], v[72:75], v[112:115]
    v_exp_f32 v132, v132
    v_mfma_f32_16x16x32_bf16 v[120:123], v[160:163], v[88:91], v[120:123]
    v_exp_f32 v133, v133
    ds_read_b64_tr_b16 v[192:193], v226 offset:8192
    ds_read_b64_tr_b16 v[194:195], v226 offset:12288
    s_waitcnt lgkmcnt(10)
    v_mfma_f32_16x16x32_bf16 v[112:115], v[164:167], v[76:79], v[112:115]
    v_exp_f32 v134, v134
    v_mfma_f32_16x16x32_bf16 v[120:123], v[164:167], v[92:95], v[120:123]
    v_exp_f32 v135, v135
    ds_read_b64_tr_b16 v[196:197], v227 offset:8192
    ds_read_b64_tr_b16 v[198:199], v227 offset:12288
    s_waitcnt lgkmcnt(11)
    v_mfma_f32_16x16x32_bf16 v[116:119], v[168:171], v[64:67], v[96:99]
    v_exp_f32 v136, v136
    v_mfma_f32_16x16x32_bf16 v[124:127], v[168:171], v[80:83], v[100:103]
    v_exp_f32 v137, v137
    ds_read_b64_tr_b16 v[200:201], v228 offset:8192
    ds_read_b64_tr_b16 v[202:203], v228 offset:12288
L_stub49:
    s_cbranch_execz L_dry_back
    s_waitcnt lgkmcnt(12)
    v_mfma_f32_16x16x32_bf16 v[116:119], v[172:175], v[68:71], v[116:119]
    v_exp_f32 v138, v138
    v_cvt_pk_bf16_f32 v144, v128, v129
    v_mfma_f32_16x16x32_bf16 v[124:127], v[172:175], v[84:87], v[124:127]
    v_exp_f32 v139, v139
    v_cvt_pk_bf16_f32 v145, v130, v131
    s_waitcnt lgkmcnt(11)
    v_mfma_f32_16x16x32_bf16 v[116:119], v[176:179], v[72:75], v[116:119]
    v_exp_f32 v140, v140
    v_cvt_pk_bf16_f32 v146, v132, v133
    v_mfma_f32_16x16x32_bf16 v[124:127], v[176:179], v[88:91], v[124:127]
    v_exp_f32 v141, v141
    v_cvt_pk_bf16_f32 v147, v134, v135
    s_waitcnt lgkmcnt(10)
    v_mfma_f32_16x16x32_bf16 v[116:119], v[180:183], v[76:79], v[116:119]
    v_exp_f32 v142, v142
    v_mfma_f32_16x16x32_bf16 v[124:127], v[180:183], v[92:95], v[124:127]
    v_exp_f32 v143, v143
    v_cvt_pk_bf16_f32 v148, v136, v137
    v_cvt_pk_bf16_f32 v149, v138, v139
    v_cvt_pk_bf16_f32 v150, v140, v141
    v_cvt_pk_bf16_f32 v151, v142, v143
    s_waitcnt lgkmcnt(8)
    v_mfma_f32_16x16x32_bf16 v[0:3], v[184:187], v[144:147], v[0:3]
    ds_read_b64_tr_b16 v[204:205], v229 offset:8192
    v_mfma_f32_16x16x32_bf16 v[32:35], v[184:187], v[148:151], v[32:35]
    ds_read_b64_tr_b16 v[206:207], v229 offset:12288
    s_waitcnt lgkmcnt(8)
    v_mfma_f32_16x16x32_bf16 v[4:7], v[188:191], v[144:147], v[4:7]
    ds_read_b64_tr_b16 v[208:209], v230 offset:8192
    v_mfma_f32_16x16x32_bf16 v[36:39], v[188:191], v[148:151], v[36:39]
    ds_read_b64_tr_b16 v[210:211], v230 offset:12288
    s_waitcnt lgkmcnt(8)
    v_mfma_f32_16x16x32_bf16 v[8:11], v[192:195], v[144:147], v[8:11]
    ds_read_b64_tr_b16 v[212:213], v231 offset:8192
    v_mfma_f32_16x16x32_bf16 v[40:43], v[192:195], v[148:151], v[40:43]
L_stub50:
    s_cbranch_execz L_dry_back
    ds_read_b64_tr_b16 v[214:215], v231 offset:12288
    s_waitcnt lgkmcnt(8)
    v_mfma_f32_16x16x32_bf16 v[12:15], v[196:199], v[144:147], v[12:15]
    ds_read_b128 v[152:155], v220 offset:8192
    v_mfma_f32_16x16x32_bf16 v[44:47], v[196:199], v[148:151], v[44:47]
    ds_read_b128 v[156:159], v221 offset:8192
    s_waitcnt lgkmcnt(8)
    v_mfma_f32_16x16x32_bf16 v[16:19], v[200:203], v[144:147], v[16:19]
    ds_read_b128 v[160:163], v222 offset:8192
    v_max3_f32 v232, v112, v113, v114
    v_mfma_f32_16x16x32_bf16 v[48:51], v[200:203], v[148:151], v[48:51]
    ds_read_b128 v[164:167], v223 offset:8192
    v_max3_f32 v232, v232, v115, v116
    s_waitcnt lgkmcnt(8)
    v_mfma_f32_16x16x32_bf16 v[20:23], v[204:207], v[144:147], v[20:23]
    ds_read_b128 v[168:171], v220 offset:12288
    v_max3_f32 v232, v232, v117, v118
    v_mfma_f32_16x16x32_bf16 v[52:55], v[204:207], v[148:151], v[52:55]
    ds_read_b128 v[172:175], v221 offset:12288
    v_max3_f32 v232, v232, v119, v120
    s_waitcnt lgkmcnt(8)
    v_mfma_f32_16x16x32_bf16 v[24:27], v[208:211], v[144:147], v[24:27]
    ds_read_b128 v[176:179], v222 offset:12288
    v_max3_f32 v232, v232, v121, v122
    v_mfma_f32_16x16x32_bf16 v[56:59], v[208:211], v[148:151], v[56:59]
    ds_read_b128 v[180:183], v223 offset:12288
    v_max3_f32 v232, v232, v123, v124
    s_waitcnt lgkmcnt(8)
    v_mfma_f32_16x16x32_bf16 v[28:31], v[212:215], v[144:147], v[28:31]
    v_max3_f32 v232, v232, v125, v126
    v_mfma_f32_16x16x32_bf16 v[60:63], v[212:215], v[148:151], v[60:63]
    v_max_f32 v232, v232, v127
    v_mfma_f32_16x16x32_bf16 v[104:107], v[216:219], v[144:147], v[104:107]
    v_add_u32 v224, s44, v224
    v_add_u32 v225, s44, v225
    v_add_u32 v226, s44, v226
L_stub51:
    s_cbranch_execz L_dry_back
    v_add_u32 v227, s44, v227
    v_add_u32 v228, s44, v228
    v_add_u32 v229, s44, v229
    v_mfma_f32_16x16x32_bf16 v[108:111], v[216:219], v[148:151], v[108:111]
    v_add_u32 v230, s44, v230
    v_add_u32 v231, s44, v231
    v_add_u32 v220, s44, v220
    v_add_u32 v221, s44, v221
    v_add_u32 v222, s44, v222
    v_add_u32 v223, s44, v223
    v_cmp_lt_f32 vcc, s58, v232
    s_cbranch_vccnz L_m_rareA
L_m_retA:
    s_add_u32 s53, s53, 1
    s_waitcnt lgkmcnt(0)
    s_branch L_m_loop
L_m_last:
    v_exp_f32 v128, v128
    v_exp_f32 v129, v129
    ds_read_b64_tr_b16 v[184:185], v224 offset:8192
    ds_read_b64_tr_b16 v[186:187], v224 offset:12288
    v_exp_f32 v130, v130
    v_exp_f32 v131, v131
    ds_read_b64_tr_b16 v[188:189], v225 offset:8192
    ds_read_b64_tr_b16 v[190:191], v225 offset:12288
    v_exp_f32 v132, v132
    v_exp_f32 v133, v133
    ds_read_b64_tr_b16 v[192:193], v226 offset:8192
    ds_read_b64_tr_b16 v[194:195], v226 offset:12288
    v_exp_f32 v134, v134
    v_exp_f32 v135, v135
    ds_read_b64_tr_b16 v[196:197], v227 offset:8192
    s_waitcnt lgkmcnt(14)
    ds_read_b64_tr_b16 v[198:199], v227 offset:12288
    v_exp_f32 v136, v136
    v_exp_f32 v137, v137
    s_waitcnt lgkmcnt(14)
    ds_read_b64_tr_b16 v[200:201], v228 offset:8192
    s_waitcnt lgkmcnt(14)
    ds_read_b64_tr_b16 v[202:203], v228 offset:12288
    v_exp_f32 v138, v138
    v_cvt_pk_bf16_f32 v144, v128, v129
    v_exp_f32 v139, v139
    v_cvt_pk_bf16_f32 v145, v130, v131
    v_exp_f32 v140, v140
    v_cvt_pk_bf16_f32 v146, v132, v133
    v_exp_f32 v141, v141
    v_cvt_pk_bf16_f32 v147, v134, v135
    v_exp_f32 v142, v142
    v_exp_f32 v143, v143
L_stub52:
    s_cbranch_execz L_dry_back
    v_cvt_pk_bf16_f32 v148, v136, v137
    v_cvt_pk_bf16_f32 v149, v138, v139
    v_cvt_pk_bf16_f32 v150, v140, v141
    v_cvt_pk_bf16_f32 v151, v142, v143
    s_waitcnt lgkmcnt(8)
    v_mfma_f32_16x16x32_bf16 v[0:3], v[184:187], v[144:147], v[0:3]
    ds_read_b64_tr_b16 v[204:205], v229 offset:8192
    v_mfma_f32_16x16x32_bf16 v[32:35], v[184:187], v[148:151], v[32:35]
    ds_read_b64_tr_b16 v[206:207], v229 offset:12288
    s_waitcnt lgkmcnt(8)
    v_mfma_f32_16x16x32_bf16 v[4:7], v[188:191], v[144:147], v[4:7]
    ds_read_b64_tr_b16 v[208:209], v230 offset:8192
    v_mfma_f32_16x16x32_bf16 v[36:39], v[188:191], v[148:151], v[36:39]
    ds_read_b64_tr_b16 v[210:211], v230 offset:12288
    s_waitcnt lgkmcnt(8)
    v_mfma_f32_16x16x32_bf16 v[8:11], v[192:195], v[144:147], v[8:11]
    ds_read_b64_tr_b16 v[212:213], v231 offset:8192
    v_mfma_f32_16x16x32_bf16 v[40:43], v[192:195], v[148:151], v[40:43]
    ds_read_b64_tr_b16 v[214:215], v231 offset:12288
    s_waitcnt lgkmcnt(8)
    v_mfma_f32_16x16x32_bf16 v[12:15], v[196:199], v[144:147], v[12:15]
    v_mfma_f32_16x16x32_bf16 v[44:47], v[196:199], v[148:151], v[44:47]
    s_waitcnt lgkmcnt(6)
    v_mfma_f32_16x16x32_bf16 v[16:19], v[200:203], v[144:147], v[16:19]
    v_mfma_f32_16x16x32_bf16 v[48:51], v[200:203], v[148:151], v[48:51]
    s_waitcnt lgkmcnt(4)
    v_mfma_f32_16x16x32_bf16 v[20:23], v[204:207], v[144:147], v[20:23]
    v_mfma_f32_16x16x32_bf16 v[52:55], v[204:207], v[148:151], v[52:55]
    s_waitcnt lgkmcnt(2)
    v_mfma_f32_16x16x32_bf16 v[24:27], v[208:211], v[144:147], v[24:27]
    v_mfma_f32_16x16x32_bf16 v[56:59], v[208:211], v[148:151], v[56:59]
    s_waitcnt lgkmcnt(0)
    v_mfma_f32_16x16x32_bf16 v[28:31], v[212:215], v[144:147], v[28:31]
    v_mfma_f32_16x16x32_bf16 v[60:63], v[212:215], v[148:151], v[60:63]
    v_mfma_f32_16x16x32_bf16 v[104:107], v[216:219], v[144:147], v[104:107]
    v_mfma_f32_16x16x32_bf16 v[108:111], v[216:219], v[148:151], v[108:111]
L_stub53:
    s_cbranch_execz L_dry_back
    s_waitcnt lgkmcnt(0)
    s_mov_b32 s36, s18
    s_mov_b32 s37, s19
    s_mov_b32 s38, 16777216
    s_mov_b32 s39, 0x20000
    s_nop 1
    v_rcp_f32 v233, v104
    v_rcp_f32 v234, v108
    v_lshlrev_b32 v242, 4, v255
    s_mul_i32 s45, s41, 9
    s_lshl_b32 s44, s40, 1
    s_add_u32 s43, s45, s44
    s_mul_i32 s43, s43, 131072
    s_lshl_b32 s44, s42, 12
    s_add_u32 s43, s43, s44
    s_add_u32 s46, s43, 131072
    v_mov_b32 v246, v233
    v_mov_b32 v247, v233
    v_mov_b32 v248, v234
    v_mov_b32 v249, v234
    v_pk_mul_f32 v[0:1], v[0:1], v[246:247]
    v_pk_mul_f32 v[2:3], v[2:3], v[246:247]
    v_pk_mul_f32 v[4:5], v[4:5], v[246:247]
    v_pk_mul_f32 v[6:7], v[6:7], v[246:247]
    v_cvt_pk_bf16_f32 v64, v0, v1
    v_cvt_pk_bf16_f32 v65, v2, v3
    v_cvt_pk_bf16_f32 v66, v4, v5
    v_cvt_pk_bf16_f32 v67, v6, v7
    buffer_store_dwordx4 v[64:67], v242, s[36:39], s43 offen offset:0 sc1
    v_pk_mul_f32 v[8:9], v[8:9], v[246:247]
    v_pk_mul_f32 v[10:11], v[10:11], v[246:247]
    v_pk_mul_f32 v[12:13], v[12:13], v[246:247]
    v_pk_mul_f32 v[14:15], v[14:15], v[246:247]
    v_cvt_pk_bf16_f32 v68, v8, v9
    v_cvt_pk_bf16_f32 v69, v10, v11
    v_cvt_pk_bf16_f32 v70, v12, v13
    v_cvt_pk_bf16_f32 v71, v14, v15
    buffer_store_dwordx4 v[68:71], v242, s[36:39], s43 offen offset:1024 sc1
    v_pk_mul_f32 v[16:17], v[16:17], v[246:247]
L_stub54:
    s_cbranch_execz L_dry_back
    v_pk_mul_f32 v[18:19], v[18:19], v[246:247]
    v_pk_mul_f32 v[20:21], v[20:21], v[246:247]
    v_pk_mul_f32 v[22:23], v[22:23], v[246:247]
    v_cvt_pk_bf16_f32 v72, v16, v17
    v_cvt_pk_bf16_f32 v73, v18, v19
    v_cvt_pk_bf16_f32 v74, v20, v21
    v_cvt_pk_bf16_f32 v75, v22, v23
    buffer_store_dwordx4 v[72:75], v242, s[36:39], s43 offen offset:2048 sc1
    v_pk_mul_f32 v[24:25], v[24:25], v[246:247]
    v_pk_mul_f32 v[26:27], v[26:27], v[246:247]
    v_pk_mul_f32 v[28:29], v[28:29], v[246:247]
    v_pk_mul_f32 v[30:31], v[30:31], v[246:247]
    v_cvt_pk_bf16_f32 v76, v24, v25
    v_cvt_pk_bf16_f32 v77, v26, v27
    v_cvt_pk_bf16_f32 v78, v28, v29
    v_cvt_pk_bf16_f32 v79, v30, v31
    buffer_store_dwordx4 v[76:79], v242, s[36:39], s43 offen offset:3072 sc1
    v_pk_mul_f32 v[32:33], v[32:33], v[248:249]
    v_pk_mul_f32 v[34:35], v[34:35], v[248:249]
    v_pk_mul_f32 v[36:37], v[36:37], v[248:249]
    v_pk_mul_f32 v[38:39], v[38:39], v[248:249]
    v_cvt_pk_bf16_f32 v80, v32, v33
    v_cvt_pk_bf16_f32 v81, v34, v35
    v_cvt_pk_bf16_f32 v82, v36, v37
    v_cvt_pk_bf16_f32 v83, v38, v39
    buffer_store_dwordx4 v[80:83], v242, s[36:39], s46 offen offset:0 sc1
    v_pk_mul_f32 v[40:41], v[40:41], v[248:249]
    v_pk_mul_f32 v[42:43], v[42:43], v[248:249]
    v_pk_mul_f32 v[44:45], v[44:45], v[248:249]
    v_pk_mul_f32 v[46:47], v[46:47], v[248:249]
    v_cvt_pk_bf16_f32 v84, v40, v41
    v_cvt_pk_bf16_f32 v85, v42, v43
L_stub55:
    s_cbranch_execz L_dry_back
    v_cvt_pk_bf16_f32 v86, v44, v45
    v_cvt_pk_bf16_f32 v87, v46, v47
    buffer_store_dwordx4 v[84:87], v242, s[36:39], s46 offen offset:1024 sc1
    v_pk_mul_f32 v[48:49], v[48:49], v[248:249]
    v_pk_mul_f32 v[50:51], v[50:51], v[248:249]
    v_pk_mul_f32 v[52:53], v[52:53], v[248:249]
    v_pk_mul_f32 v[54:55], v[54:55], v[248:249]
    v_cvt_pk_bf16_f32 v88, v48, v49
    v_cvt_pk_bf16_f32 v89, v50, v51
    v_cvt_pk_bf16_f32 v90, v52, v53
    v_cvt_pk_bf16_f32 v91, v54, v55
    buffer_store_dwordx4 v[88:91], v242, s[36:39], s46 offen offset:2048 sc1
    v_pk_mul_f32 v[56:57], v[56:57], v[248:249]
    v_pk_mul_f32 v[58:59], v[58:59], v[248:249]
    v_pk_mul_f32 v[60:61], v[60:61], v[248:249]
    v_pk_mul_f32 v[62:63], v[62:63], v[248:249]
    v_cvt_pk_bf16_f32 v92, v56, v57
    v_cvt_pk_bf16_f32 v93, v58, v59
    v_cvt_pk_bf16_f32 v94, v60, v61
    v_cvt_pk_bf16_f32 v95, v62, v63
    buffer_store_dwordx4 v[92:95], v242, s[36:39], s46 offen offset:3072 sc1
    s_mul_i32 s47, s40, 12288
    s_add_u32 s47, s47, 49152
    v_add_u32 v243, s47, v242
    v_lshlrev_b32 v244, 3, v255
    v_add_u32 v244, s47, v244
    s_waitcnt lgkmcnt(0)
    s_barrier
    ds_read_b64 v[128:129], v244 offset:2048
    ds_read_b64 v[130:131], v244 offset:4608
    ds_read_b64 v[132:133], v244 offset:7168
    ds_read_b64 v[134:135], v244 offset:9728
    ds_read_b128 v[96:99], v243 offset:0
    ds_read_b128 v[100:103], v243 offset:1024
L_stub56:
    s_cbranch_execz L_dry_back
    ds_read_b128 v[104:107], v243 offset:2560
    ds_read_b128 v[108:111], v243 offset:3584
    ds_read_b128 v[112:115], v243 offset:5120
    ds_read_b128 v[116:119], v243 offset:6144
    ds_read_b128 v[120:123], v243 offset:7680
    ds_read_b128 v[124:127], v243 offset:8704
    s_waitcnt lgkmcnt(0)
    v_min_f32 v232, v128, v130
    v_min3_f32 v232, v232, v132, v134
    v_sub_f32 v128, v232, v128
    v_sub_f32 v130, v232, v130
    v_sub_f32 v132, v232, v132
    v_sub_f32 v134, v232, v134
    v_exp_f32 v128, v128
    v_exp_f32 v130, v130
    v_exp_f32 v132, v132
    v_exp_f32 v134, v134
    s_nop 0
    v_mul_f32 v233, v128, v129
    v_fmac_f32 v233, v130, v131
    v_fmac_f32 v233, v132, v133
    v_fmac_f32 v233, v134, v135
    v_rcp_f32 v233, v233
    v_mul_f32 v0, v128, v96
    v_fmac_f32 v0, v130, v104
    v_fmac_f32 v0, v132, v112
    v_fmac_f32 v0, v134, v120
    v_mul_f32 v1, v128, v97
    v_fmac_f32 v1, v130, v105
    v_fmac_f32 v1, v132, v113
    v_fmac_f32 v1, v134, v121
    v_mul_f32 v2, v128, v98
    v_fmac_f32 v2, v130, v106
    v_fmac_f32 v2, v132, v114
    v_fmac_f32 v2, v134, v122
    v_mul_f32 v3, v128, v99
    v_fmac_f32 v3, v130, v107
    v_fmac_f32 v3, v132, v115
    v_fmac_f32 v3, v134, v123
    v_mul_f32 v4, v128, v100
    v_fmac_f32 v4, v130, v108
    v_fmac_f32 v4, v132, v116
    v_fmac_f32 v4, v134, v124
    v_mul_f32 v5, v128, v101
    v_fmac_f32 v5, v130, v109
    v_fmac_f32 v5, v132, v117
    v_fmac_f32 v5, v134, v125
    v_mul_f32 v6, v128, v102
    v_fmac_f32 v6, v130, v110
    v_fmac_f32 v6, v132, v118
    v_fmac_f32 v6, v134, v126
    v_mul_f32 v7, v128, v103
    v_fmac_f32 v7, v130, v111
    v_fmac_f32 v7, v132, v119
    v_fmac_f32 v7, v134, v127
L_stub57:
    s_cbranch_execz L_dry_back
    v_mul_f32 v0, v233, v0
    v_mul_f32 v1, v233, v1
    v_mul_f32 v2, v233, v2
    v_mul_f32 v3, v233, v3
    v_mul_f32 v4, v233, v4
    v_mul_f32 v5, v233, v5
    v_mul_f32 v6, v233, v6
    v_mul_f32 v7, v233, v7
    v_cvt_pk_bf16_f32 v8, v0, v1
    v_cvt_pk_bf16_f32 v9, v2, v3
    v_cvt_pk_bf16_f32 v10, v4, v5
    v_cvt_pk_bf16_f32 v11, v6, v7
    s_add_u32 s43, s45, 8
    s_mul_i32 s43, s43, 131072
    s_add_u32 s43, s43, s44
    s_lshl_b32 s44, s40, 10
    s_add_u32 s43, s43, s44
    buffer_store_dwordx4 v[8:11], v242, s[36:39], s43 offen sc1
    s_branch L_tail_m
L_m_rareA:
    s_nop 15
    v_max3_f32 v232, v112, v113, v114
    v_max3_f32 v234, v120, v121, v122
    v_max3_f32 v232, v232, v115, v116
    v_max3_f32 v234, v234, v123, v124
    v_max3_f32 v232, v232, v117, v118
    v_max3_f32 v234, v234, v125, v126
    v_max_f32 v232, v232, v119
    v_max_f32 v234, v234, v127
    v_mov_b32 v233, v232
    v_mov_b32 v144, v234
    s_nop 0
    v_permlane32_swap_b32 v232, v233
    v_permlane32_swap_b32 v234, v144
    s_nop 0
    v_max_f32 v232, v232, v233
    v_max_f32 v234, v234, v144
    v_mov_b32 v233, v232
    v_mov_b32 v144, v234
    s_nop 0
    v_permlane16_swap_b32 v232, v233
    v_permlane16_swap_b32 v234, v144
    s_nop 0
    v_max_f32 v232, v232, v233
    v_max_f32 v234, v234, v144
    v_max_f32 v232, 0, v232
    v_exp_f32 v233, -v232
    v_sub_f32 v112, v112, v232
    v_sub_f32 v113, v113, v232
    v_sub_f32 v114, v114, v232
    v_sub_f32 v115, v115, v232
L_stub58:
    s_cbranch_execz L_dry_back
    v_sub_f32 v116, v116, v232
    v_sub_f32 v117, v117, v232
    v_sub_f32 v118, v118, v232
    v_sub_f32 v119, v119, v232
    v_sub_f32 v96, v96, v232
    v_sub_f32 v97, v97, v232
    v_sub_f32 v98, v98, v232
    v_sub_f32 v99, v99, v232
    v_mul_f32 v104, v233, v104
    v_mul_f32 v105, v233, v105
    v_mul_f32 v106, v233, v106
    v_mul_f32 v107, v233, v107
    v_mul_f32 v0, v233, v0
    v_mul_f32 v1, v233, v1
    v_mul_f32 v2, v233, v2
    v_mul_f32 v3, v233, v3
    v_mul_f32 v4, v233, v4
    v_mul_f32 v5, v233, v5
    v_mul_f32 v6, v233, v6
    v_mul_f32 v7, v233, v7
    v_mul_f32 v8, v233, v8
    v_mul_f32 v9, v233, v9
    v_mul_f32 v10, v233, v10
    v_mul_f32 v11, v233, v11
    v_mul_f32 v12, v233, v12
    v_mul_f32 v13, v233, v13
    v_mul_f32 v14, v233, v14
    v_mul_f32 v15, v233, v15
    v_mul_f32 v16, v233, v16
    v_mul_f32 v17, v233, v17
    v_mul_f32 v18, v233, v18
    v_mul_f32 v19, v233, v19
    v_mul_f32 v20, v233, v20
    v_mul_f32 v21, v233, v21
    v_mul_f32 v22, v233, v22
    v_mul_f32 v23, v233, v23
    v_mul_f32 v24, v233, v24
    v_mul_f32 v25, v233, v25
    v_mul_f32 v26, v233, v26
    v_mul_f32 v27, v233, v27
    v_mul_f32 v28, v233, v28
    v_mul_f32 v29, v233, v29
    v_mul_f32 v30, v233, v30
    v_mul_f32 v31, v233, v31
    v_max_f32 v234, 0, v234
    v_exp_f32 v233, -v234
    v_sub_f32 v120, v120, v234
    v_sub_f32 v121, v121, v234
    v_sub_f32 v122, v122, v234
    v_sub_f32 v123, v123, v234
    v_sub_f32 v124, v124, v234
    v_sub_f32 v125, v125, v234
    v_sub_f32 v126, v126, v234
    v_sub_f32 v127, v127, v234
    v_sub_f32 v100, v100, v234
    v_sub_f32 v101, v101, v234
    v_sub_f32 v102, v102, v234
    v_sub_f32 v103, v103, v234
    v_mul_f32 v108, v233, v108
    v_mul_f32 v109, v233, v109
    v_mul_f32 v110, v233, v110
    v_mul_f32 v111, v233, v111
L_stub59:
    s_cbranch_execz L_dry_back
    v_mul_f32 v32, v233, v32
    v_mul_f32 v33, v233, v33
    v_mul_f32 v34, v233, v34
    v_mul_f32 v35, v233, v35
    v_mul_f32 v36, v233, v36
    v_mul_f32 v37, v233, v37
    v_mul_f32 v38, v233, v38
    v_mul_f32 v39, v233, v39
    v_mul_f32 v40, v233, v40
    v_mul_f32 v41, v233, v41
    v_mul_f32 v42, v233, v42
    v_mul_f32 v43, v233, v43
    v_mul_f32 v44, v233, v44
    v_mul_f32 v45, v233, v45
    v_mul_f32 v46, v233, v46
    v_mul_f32 v47, v233, v47
    v_mul_f32 v48, v233, v48
    v_mul_f32 v49, v233, v49
    v_mul_f32 v50, v233, v50
    v_mul_f32 v51, v233, v51
    v_mul_f32 v52, v233, v52
    v_mul_f32 v53, v233, v53
    v_mul_f32 v54, v233, v54
    v_mul_f32 v55, v233, v55
    v_mul_f32 v56, v233, v56
    v_mul_f32 v57, v233, v57
    v_mul_f32 v58, v233, v58
    v_mul_f32 v59, v233, v59
    v_mul_f32 v60, v233, v60
    v_mul_f32 v61, v233, v61
    v_mul_f32 v62, v233, v62
    v_mul_f32 v63, v233, v63
    s_nop 1
    s_branch L_m_retA
L_m_rareB:
    s_nop 15
    v_max3_f32 v232, v128, v129, v130
    v_max3_f32 v234, v136, v137, v138
    v_max3_f32 v232, v232, v131, v132
    v_max3_f32 v234, v234, v139, v140
    v_max3_f32 v232, v232, v133, v134
    v_max3_f32 v234, v234, v141, v142
    v_max_f32 v232, v232, v135
    v_max_f32 v234, v234, v143
    v_mov_b32 v233, v232
    v_mov_b32 v144, v234
    s_nop 0
    v_permlane32_swap_b32 v232, v233
    v_permlane32_swap_b32 v234, v144
    s_nop 0
    v_max_f32 v232, v232, v233
    v_max_f32 v234, v234, v144
    v_mov_b32 v233, v232
    v_mov_b32 v144, v234
    s_nop 0
    v_permlane16_swap_b32 v232, v233
    v_permlane16_swap_b32 v234, v144
    s_nop 0
L_stub60:
    s_cbranch_execz L_dry_back
    v_max_f32 v232, v232, v233
    v_max_f32 v234, v234, v144
    v_max_f32 v232, 0, v232
    v_exp_f32 v233, -v232
    v_sub_f32 v128, v128, v232
    v_sub_f32 v129, v129, v232
    v_sub_f32 v130, v130, v232
    v_sub_f32 v131, v131, v232
    v_sub_f32 v132, v132, v232
    v_sub_f32 v133, v133, v232
    v_sub_f32 v134, v134, v232
    v_sub_f32 v135, v135, v232
    v_sub_f32 v96, v96, v232
    v_sub_f32 v97, v97, v232
    v_sub_f32 v98, v98, v232
    v_sub_f32 v99, v99, v232
    v_mul_f32 v104, v233, v104
    v_mul_f32 v105, v233, v105
    v_mul_f32 v106, v233, v106
    v_mul_f32 v107, v233, v107
    v_mul_f32 v0, v233, v0
    v_mul_f32 v1, v233, v1
    v_mul_f32 v2, v233, v2
    v_mul_f32 v3, v233, v3
    v_mul_f32 v4, v233, v4
    v_mul_f32 v5, v233, v5
    v_mul_f32 v6, v233, v6
    v_mul_f32 v7, v233, v7
    v_mul_f32 v8, v233, v8
    v_mul_f32 v9, v233, v9
    v_mul_f32 v10, v233, v10
    v_mul_f32 v11, v233, v11
    v_mul_f32 v12, v233, v12
    v_mul_f32 v13, v233, v13
    v_mul_f32 v14, v233, v14
    v_mul_f32 v15, v233, v15
    v_mul_f32 v16, v233, v16
    v_mul_f32 v17, v233, v17
    v_mul_f32 v18, v233, v18
    v_mul_f32 v19, v233, v19
    v_mul_f32 v20, v233, v20
    v_mul_f32 v21, v233, v21
    v_mul_f32 v22, v233, v22
    v_mul_f32 v23, v233, v23
    v_mul_f32 v24, v233, v24
    v_mul_f32 v25, v233, v25
    v_mul_f32 v26, v233, v26
    v_mul_f32 v27, v233, v27
    v_mul_f32 v28, v233, v28
    v_mul_f32 v29, v233, v29
    v_mul_f32 v30, v233, v30
    v_mul_f32 v31, v233, v31
    v_max_f32 v234, 0, v234
    v_exp_f32 v233, -v234
    v_sub_f32 v136, v136, v234
    v_sub_f32 v137, v137, v234
    v_sub_f32 v138, v138, v234
    v_sub_f32 v139, v139, v234
    v_sub_f32 v140, v140, v234
    v_sub_f32 v141, v141, v234
    v_sub_f32 v142, v142, v234
L_stub61:
    s_cbranch_execz L_dry_back
    v_sub_f32 v143, v143, v234
    v_sub_f32 v100, v100, v234
    v_sub_f32 v101, v101, v234
    v_sub_f32 v102, v102, v234
    v_sub_f32 v103, v103, v234
    v_mul_f32 v108, v233, v108
    v_mul_f32 v109, v233, v109
    v_mul_f32 v110, v233, v110
    v_mul_f32 v111, v233, v111
    v_mul_f32 v32, v233, v32
    v_mul_f32 v33, v233, v33
    v_mul_f32 v34, v233, v34
    v_mul_f32 v35, v233, v35
    v_mul_f32 v36, v233, v36
    v_mul_f32 v37, v233, v37
    v_mul_f32 v38, v233, v38
    v_mul_f32 v39, v233, v39
    v_mul_f32 v40, v233, v40
    v_mul_f32 v41, v233, v41
    v_mul_f32 v42, v233, v42
    v_mul_f32 v43, v233, v43
    v_mul_f32 v44, v233, v44
    v_mul_f32 v45, v233, v45
    v_mul_f32 v46, v233, v46
    v_mul_f32 v47, v233, v47
    v_mul_f32 v48, v233, v48
    v_mul_f32 v49, v233, v49
    v_mul_f32 v50, v233, v50
    v_mul_f32 v51, v233, v51
    v_mul_f32 v52, v233, v52
    v_mul_f32 v53, v233, v53
    v_mul_f32 v54, v233, v54
    v_mul_f32 v55, v233, v55
    v_mul_f32 v56, v233, v56
    v_mul_f32 v57, v233, v57
    v_mul_f32 v58, v233, v58
    v_mul_f32 v59, v233, v59
    v_mul_f32 v60, v233, v60
    v_mul_f32 v61, v233, v61
    v_mul_f32 v62, v233, v62
    v_mul_f32 v63, v233, v63
    s_nop 1
    s_branch L_m_retB
L_tail_h:
    v_lshrrev_b32 v48, 3, v255
    v_mul_u32_u24 v48, 1280, v48
    v_lshrrev_b32 v49, 4, v255
    v_lshlrev_b32 v49, 1, v49
    v_and_b32 v50, 7, v255
    v_xor_b32 v49, v49, v50
    v_lshl_add_u32 v252, v49, 4, v48
    s_mul_i32 s44, s59, 12288
    s_lshl_b32 s43, s58, 3
    s_add_u32 s43, s43, s40
    s_mul_i32 s47, s43, 327680
    s_lshl_b32 s43, s61, 7
    s_add_u32 s47, s47, s43
    v_mov_b32 v254, 0
    v_mov_b32 v134, 1
    s_lshr_b32 s43, s2, 3
L_stub62:
    s_cbranch_execz L_dry_back
    s_cmp_lt_u32 s43, 30
    s_cbranch_scc1 L_act_h
    s_branch L_fin
L_act_h:
    s_mov_b32 s43, s58
    s_lshl_b32 s50, s60, 1
    s_add_u32 s51, s50, s43
    s_add_u32 s50, s50, 1
    s_sub_u32 s50, s50, s43
    s_lshl_b32 s43, s58, 3
    s_add_u32 s43, s43, s40
    s_lshl_b32 s43, s43, 13
    s_mul_i32 s48, s50, 393216
    s_add_u32 s48, s48, s43
    s_mul_i32 s49, s51, 393216
    s_add_u32 s49, s49, s43
    s_lshl_b32 s43, s58, 2
    s_lshr_b32 s45, s40, 1
    s_add_u32 s43, s43, s45
    s_lshl_b32 s43, s43, 7
    s_add_u32 s43, s43, 12582912
    s_mul_i32 s56, s50, 43
    s_lshr_b32 s56, s56, 7
    s_lshl_b32 s56, s56, 10
    s_add_u32 s56, s56, s43
    s_mul_i32 s57, s51, 43
    s_lshr_b32 s57, s57, 7
    s_lshl_b32 s57, s57, 10
    s_add_u32 s57, s57, s43
    v_and_b32 v132, 7, v255
    s_and_b32 s43, s40, 1
    s_lshl_b32 s43, s43, 5
    v_lshl_add_u32 v132, v132, 2, s43
    v_lshlrev_b32 v253, 4, v255
    buffer_load_dword v133, v132, s[36:39], s56 offen sc1
    v_mov_b32 v0, 0
    v_mov_b32 v1, 0
    v_mov_b32 v2, 0
    v_mov_b32 v3, 0
    v_mov_b32 v4, 0
    v_mov_b32 v5, 0
    v_mov_b32 v6, 0
    v_mov_b32 v7, 0
    v_mov_b32 v8, 0
    v_mov_b32 v9, 0
    v_mov_b32 v10, 0
    v_mov_b32 v11, 0
    v_mov_b32 v12, 0
    v_mov_b32 v13, 0
    v_mov_b32 v14, 0
    v_mov_b32 v15, 0
    v_mov_b32 v16, 0
    v_mov_b32 v17, 0
    v_mov_b32 v18, 0
    v_mov_b32 v19, 0
    v_mov_b32 v20, 0
    v_mov_b32 v21, 0
    v_mov_b32 v22, 0
    v_mov_b32 v23, 0
L_stub63:
    s_cbranch_execz L_dry_back
    v_mov_b32 v24, 0
    v_mov_b32 v25, 0
    v_mov_b32 v26, 0
    v_mov_b32 v27, 0
    v_mov_b32 v28, 0
    v_mov_b32 v29, 0
    v_mov_b32 v30, 0
    v_mov_b32 v31, 0
    v_mov_b32 v32, 0
    v_mov_b32 v33, 0
    v_mov_b32 v34, 0
    v_mov_b32 v35, 0
    v_mov_b32 v36, 0
    v_mov_b32 v37, 0
    v_mov_b32 v38, 0
    v_mov_b32 v39, 0
    v_mov_b32 v40, 0
    v_mov_b32 v41, 0
    v_mov_b32 v42, 0
    v_mov_b32 v43, 0
    v_mov_b32 v44, 0
    v_mov_b32 v45, 0
    v_mov_b32 v46, 0
    v_mov_b32 v47, 0
    s_waitcnt vmcnt(0)
    s_mov_b32 s53, 0
L_poll_h0:
    v_cmp_ne_u32 vcc, 1, v133
    s_cbranch_vccz L_polled_h0
    s_sleep 8
    buffer_load_dword v133, v132, s[36:39], s56 offen sc1
    s_add_u32 s53, s53, 1
    s_waitcnt vmcnt(0)
    s_cmp_lt_u32 s53, 0x40000
    s_cbranch_scc1 L_poll_h0
L_polled_h0:
    buffer_load_dword v133, v132, s[36:39], s57 offen sc1
    s_add_u32 s53, s63, 0
    s_and_b32 s53, s53, 7
    s_lshl_b32 s53, s53, 10
    s_add_u32 s53, s53, s48
    buffer_load_dwordx4 v[48:51], v253, s[36:39], s53 offen sc1
    s_add_u32 s53, s53, 131072
    buffer_load_dwordx4 v[52:55], v253, s[36:39], s53 offen sc1
    s_add_u32 s53, s53, 131072
    buffer_load_dwordx4 v[56:59], v253, s[36:39], s53 offen sc1
    s_add_u32 s53, s63, 1
    s_and_b32 s53, s53, 7
    s_lshl_b32 s53, s53, 10
    s_add_u32 s53, s53, s48
    buffer_load_dwordx4 v[60:63], v253, s[36:39], s53 offen sc1
    s_add_u32 s53, s53, 131072
    buffer_load_dwordx4 v[64:67], v253, s[36:39], s53 offen sc1
    s_add_u32 s53, s53, 131072
L_stub64:
    s_cbranch_execz L_dry_back
    buffer_load_dwordx4 v[68:71], v253, s[36:39], s53 offen sc1
    s_add_u32 s53, s63, 2
    s_and_b32 s53, s53, 7
    s_lshl_b32 s53, s53, 10
    s_add_u32 s53, s53, s48
    buffer_load_dwordx4 v[72:75], v253, s[36:39], s53 offen sc1
    s_add_u32 s53, s53, 131072
    buffer_load_dwordx4 v[76:79], v253, s[36:39], s53 offen sc1
    s_add_u32 s53, s53, 131072
    buffer_load_dwordx4 v[80:83], v253, s[36:39], s53 offen sc1
    s_add_u32 s53, s63, 3
    s_and_b32 s53, s53, 7
    s_lshl_b32 s53, s53, 10
    s_add_u32 s53, s53, s48
    buffer_load_dwordx4 v[84:87], v253, s[36:39], s53 offen sc1
    s_add_u32 s53, s53, 131072
    buffer_load_dwordx4 v[88:91], v253, s[36:39], s53 offen sc1
    s_add_u32 s53, s53, 131072
    buffer_load_dwordx4 v[92:95], v253, s[36:39], s53 offen sc1
    s_setprio 3
    s_waitcnt vmcnt(9)
    v_mfma_f32_16x16x32_bf16 v[0:3], v[136:139], v[48:51], v[0:3]
    s_add_u32 s53, s63, 4
    s_and_b32 s53, s53, 7
    s_lshl_b32 s53, s53, 10
    s_add_u32 s53, s53, s48
    v_mfma_f32_16x16x32_bf16 v[4:7], v[136:139], v[52:55], v[4:7]
    buffer_load_dwordx4 v[96:99], v253, s[36:39], s53 offen sc1
    v_mfma_f32_16x16x32_bf16 v[8:11], v[136:139], v[56:59], v[8:11]
    s_add_u32 s53, s53, 131072
    buffer_load_dwordx4 v[100:103], v253, s[36:39], s53 offen sc1
    v_mfma_f32_16x16x32_bf16 v[12:15], v[140:143], v[48:51], v[12:15]
    s_add_u32 s53, s53, 131072
    buffer_load_dwordx4 v[104:107], v253, s[36:39], s53 offen sc1
    v_mfma_f32_16x16x32_bf16 v[16:19], v[140:143], v[52:55], v[16:19]
    v_mfma_f32_16x16x32_bf16 v[20:23], v[140:143], v[56:59], v[20:23]
    v_mfma_f32_16x16x32_bf16 v[24:27], v[144:147], v[48:51], v[24:27]
    v_mfma_f32_16x16x32_bf16 v[28:31], v[144:147], v[52:55], v[28:31]
L_stub65:
    s_cbranch_execz L_dry_back
    v_mfma_f32_16x16x32_bf16 v[32:35], v[144:147], v[56:59], v[32:35]
    v_mfma_f32_16x16x32_bf16 v[36:39], v[148:151], v[48:51], v[36:39]
    v_mfma_f32_16x16x32_bf16 v[40:43], v[148:151], v[52:55], v[40:43]
    v_mfma_f32_16x16x32_bf16 v[44:47], v[148:151], v[56:59], v[44:47]
    s_setprio 3
    s_waitcnt vmcnt(9)
    v_mfma_f32_16x16x32_bf16 v[0:3], v[152:155], v[60:63], v[0:3]
    s_add_u32 s53, s63, 5
    s_and_b32 s53, s53, 7
    s_lshl_b32 s53, s53, 10
    s_add_u32 s53, s53, s48
    v_mfma_f32_16x16x32_bf16 v[4:7], v[152:155], v[64:67], v[4:7]
    buffer_load_dwordx4 v[48:51], v253, s[36:39], s53 offen sc1
    v_mfma_f32_16x16x32_bf16 v[8:11], v[152:155], v[68:71], v[8:11]
    s_add_u32 s53, s53, 131072
    buffer_load_dwordx4 v[52:55], v253, s[36:39], s53 offen sc1
    v_mfma_f32_16x16x32_bf16 v[12:15], v[156:159], v[60:63], v[12:15]
    s_add_u32 s53, s53, 131072
    buffer_load_dwordx4 v[56:59], v253, s[36:39], s53 offen sc1
    v_mfma_f32_16x16x32_bf16 v[16:19], v[156:159], v[64:67], v[16:19]
    v_mfma_f32_16x16x32_bf16 v[20:23], v[156:159], v[68:71], v[20:23]
    v_mfma_f32_16x16x32_bf16 v[24:27], v[160:163], v[60:63], v[24:27]
    v_mfma_f32_16x16x32_bf16 v[28:31], v[160:163], v[64:67], v[28:31]
    v_mfma_f32_16x16x32_bf16 v[32:35], v[160:163], v[68:71], v[32:35]
    v_mfma_f32_16x16x32_bf16 v[36:39], v[164:167], v[60:63], v[36:39]
    v_mfma_f32_16x16x32_bf16 v[40:43], v[164:167], v[64:67], v[40:43]
    v_mfma_f32_16x16x32_bf16 v[44:47], v[164:167], v[68:71], v[44:47]
    s_setprio 3
    s_waitcnt vmcnt(9)
    v_mfma_f32_16x16x32_bf16 v[0:3], v[168:171], v[72:75], v[0:3]
    s_add_u32 s53, s63, 6
    s_and_b32 s53, s53, 7
    s_lshl_b32 s53, s53, 10
    s_add_u32 s53, s53, s48
    v_mfma_f32_16x16x32_bf16 v[4:7], v[168:171], v[76:79], v[4:7]
    buffer_load_dwordx4 v[60:63], v253, s[36:39], s53 offen sc1
    v_mfma_f32_16x16x32_bf16 v[8:11], v[168:171], v[80:83], v[8:11]
    s_add_u32 s53, s53, 131072
L_stub66:
    s_cbranch_execz L_dry_back
    buffer_load_dwordx4 v[64:67], v253, s[36:39], s53 offen sc1
    v_mfma_f32_16x16x32_bf16 v[12:15], v[172:175], v[72:75], v[12:15]
    s_add_u32 s53, s53, 131072
    buffer_load_dwordx4 v[68:71], v253, s[36:39], s53 offen sc1
    v_mfma_f32_16x16x32_bf16 v[16:19], v[172:175], v[76:79], v[16:19]
    v_mfma_f32_16x16x32_bf16 v[20:23], v[172:175], v[80:83], v[20:23]
    v_mfma_f32_16x16x32_bf16 v[24:27], v[176:179], v[72:75], v[24:27]
    v_mfma_f32_16x16x32_bf16 v[28:31], v[176:179], v[76:79], v[28:31]
    v_mfma_f32_16x16x32_bf16 v[32:35], v[176:179], v[80:83], v[32:35]
    v_mfma_f32_16x16x32_bf16 v[36:39], v[180:183], v[72:75], v[36:39]
    v_mfma_f32_16x16x32_bf16 v[40:43], v[180:183], v[76:79], v[40:43]
    v_mfma_f32_16x16x32_bf16 v[44:47], v[180:183], v[80:83], v[44:47]
    s_setprio 3
    s_waitcnt vmcnt(9)
    v_mfma_f32_16x16x32_bf16 v[0:3], v[184:187], v[84:87], v[0:3]
    s_add_u32 s53, s63, 7
    s_and_b32 s53, s53, 7
    s_lshl_b32 s53, s53, 10
    s_add_u32 s53, s53, s48
    v_mfma_f32_16x16x32_bf16 v[4:7], v[184:187], v[88:91], v[4:7]
    buffer_load_dwordx4 v[72:75], v253, s[36:39], s53 offen sc1
    v_mfma_f32_16x16x32_bf16 v[8:11], v[184:187], v[92:95], v[8:11]
    s_add_u32 s53, s53, 131072
    buffer_load_dwordx4 v[76:79], v253, s[36:39], s53 offen sc1
    v_mfma_f32_16x16x32_bf16 v[12:15], v[188:191], v[84:87], v[12:15]
    s_add_u32 s53, s53, 131072
    buffer_load_dwordx4 v[80:83], v253, s[36:39], s53 offen sc1
    v_mfma_f32_16x16x32_bf16 v[16:19], v[188:191], v[88:91], v[16:19]
    v_mfma_f32_16x16x32_bf16 v[20:23], v[188:191], v[92:95], v[20:23]
    v_mfma_f32_16x16x32_bf16 v[24:27], v[192:195], v[84:87], v[24:27]
    v_mfma_f32_16x16x32_bf16 v[28:31], v[192:195], v[88:91], v[28:31]
    v_mfma_f32_16x16x32_bf16 v[32:35], v[192:195], v[92:95], v[32:35]
    v_mfma_f32_16x16x32_bf16 v[36:39], v[196:199], v[84:87], v[36:39]
    v_mfma_f32_16x16x32_bf16 v[40:43], v[196:199], v[88:91], v[40:43]
L_stub67:
    s_cbranch_execz L_dry_back
    v_mfma_f32_16x16x32_bf16 v[44:47], v[196:199], v[92:95], v[44:47]
    s_setprio 2
    s_waitcnt vmcnt(9)
    v_mfma_f32_16x16x32_bf16 v[0:3], v[200:203], v[96:99], v[0:3]
    s_mov_b32 s53, 0
L_poll_h1:
    v_cmp_ne_u32 vcc, 1, v133
    s_cbranch_vccz L_polled_h1
    s_sleep 8
    buffer_load_dword v133, v132, s[36:39], s57 offen sc1
    s_add_u32 s53, s53, 1
    s_waitcnt vmcnt(0)
    s_cmp_lt_u32 s53, 0x40000
    s_cbranch_scc1 L_poll_h1
L_polled_h1:
    v_mfma_f32_16x16x32_bf16 v[4:7], v[200:203], v[100:103], v[4:7]
    s_add_u32 s53, s63, 0
    s_and_b32 s53, s53, 7
    s_lshl_b32 s53, s53, 10
    s_add_u32 s53, s53, s49
    v_mfma_f32_16x16x32_bf16 v[8:11], v[200:203], v[104:107], v[8:11]
    buffer_load_dwordx4 v[84:87], v253, s[36:39], s53 offen sc1
    v_mfma_f32_16x16x32_bf16 v[12:15], v[204:207], v[96:99], v[12:15]
    s_add_u32 s53, s53, 131072
    buffer_load_dwordx4 v[88:91], v253, s[36:39], s53 offen sc1
    v_mfma_f32_16x16x32_bf16 v[16:19], v[204:207], v[100:103], v[16:19]
    s_add_u32 s53, s53, 131072
    buffer_load_dwordx4 v[92:95], v253, s[36:39], s53 offen sc1
    v_mfma_f32_16x16x32_bf16 v[20:23], v[204:207], v[104:107], v[20:23]
    v_mfma_f32_16x16x32_bf16 v[24:27], v[208:211], v[96:99], v[24:27]
    v_mfma_f32_16x16x32_bf16 v[28:31], v[208:211], v[100:103], v[28:31]
    v_mfma_f32_16x16x32_bf16 v[32:35], v[208:211], v[104:107], v[32:35]
    v_mfma_f32_16x16x32_bf16 v[36:39], v[212:215], v[96:99], v[36:39]
    v_mfma_f32_16x16x32_bf16 v[40:43], v[212:215], v[100:103], v[40:43]
    v_mfma_f32_16x16x32_bf16 v[44:47], v[212:215], v[104:107], v[44:47]
    s_setprio 2
    s_waitcnt vmcnt(9)
    v_mfma_f32_16x16x32_bf16 v[0:3], v[216:219], v[48:51], v[0:3]
    s_add_u32 s53, s63, 1
    s_and_b32 s53, s53, 7
    s_lshl_b32 s53, s53, 10
    s_add_u32 s53, s53, s49
    v_mfma_f32_16x16x32_bf16 v[4:7], v[216:219], v[52:55], v[4:7]
L_stub68:
    s_cbranch_execz L_dry_back
    buffer_load_dwordx4 v[96:99], v253, s[36:39], s53 offen sc1
    v_mfma_f32_16x16x32_bf16 v[8:11], v[216:219], v[56:59], v[8:11]
    s_add_u32 s53, s53, 131072
    buffer_load_dwordx4 v[100:103], v253, s[36:39], s53 offen sc1
    v_mfma_f32_16x16x32_bf16 v[12:15], v[220:223], v[48:51], v[12:15]
    s_add_u32 s53, s53, 131072
    buffer_load_dwordx4 v[104:107], v253, s[36:39], s53 offen sc1
    v_mfma_f32_16x16x32_bf16 v[16:19], v[220:223], v[52:55], v[16:19]
    v_mfma_f32_16x16x32_bf16 v[20:23], v[220:223], v[56:59], v[20:23]
    v_mfma_f32_16x16x32_bf16 v[24:27], v[224:227], v[48:51], v[24:27]
    v_mfma_f32_16x16x32_bf16 v[28:31], v[224:227], v[52:55], v[28:31]
    v_mfma_f32_16x16x32_bf16 v[32:35], v[224:227], v[56:59], v[32:35]
    v_mfma_f32_16x16x32_bf16 v[36:39], v[228:231], v[48:51], v[36:39]
    v_mfma_f32_16x16x32_bf16 v[40:43], v[228:231], v[52:55], v[40:43]
    v_mfma_f32_16x16x32_bf16 v[44:47], v[228:231], v[56:59], v[44:47]
    s_setprio 2
    s_waitcnt vmcnt(9)
    v_mfma_f32_16x16x32_bf16 v[0:3], v[232:235], v[60:63], v[0:3]
    s_add_u32 s53, s63, 2
    s_and_b32 s53, s53, 7
    s_lshl_b32 s53, s53, 10
    s_add_u32 s53, s53, s49
    v_mfma_f32_16x16x32_bf16 v[4:7], v[232:235], v[64:67], v[4:7]
    buffer_load_dwordx4 v[48:51], v253, s[36:39], s53 offen sc1
    v_mfma_f32_16x16x32_bf16 v[8:11], v[232:235], v[68:71], v[8:11]
    s_add_u32 s53, s53, 131072
    buffer_load_dwordx4 v[52:55], v253, s[36:39], s53 offen sc1
    v_mfma_f32_16x16x32_bf16 v[12:15], v[236:239], v[60:63], v[12:15]
    s_add_u32 s53, s53, 131072
    buffer_load_dwordx4 v[56:59], v253, s[36:39], s53 offen sc1
    v_mfma_f32_16x16x32_bf16 v[16:19], v[236:239], v[64:67], v[16:19]
    v_mfma_f32_16x16x32_bf16 v[20:23], v[236:239], v[68:71], v[20:23]
    v_mfma_f32_16x16x32_bf16 v[24:27], v[240:243], v[60:63], v[24:27]
    v_mfma_f32_16x16x32_bf16 v[28:31], v[240:243], v[64:67], v[28:31]
    v_mfma_f32_16x16x32_bf16 v[32:35], v[240:243], v[68:71], v[32:35]
L_stub69:
    s_cbranch_execz L_dry_back
    v_mfma_f32_16x16x32_bf16 v[36:39], v[244:247], v[60:63], v[36:39]
    v_mfma_f32_16x16x32_bf16 v[40:43], v[244:247], v[64:67], v[40:43]
    v_mfma_f32_16x16x32_bf16 v[44:47], v[244:247], v[68:71], v[44:47]
    s_setprio 2
    s_waitcnt vmcnt(9)
    v_mfma_f32_16x16x32_bf16 v[0:3], v[108:111], v[72:75], v[0:3]
    s_add_u32 s53, s63, 3
    s_and_b32 s53, s53, 7
    s_lshl_b32 s53, s53, 10
    s_add_u32 s53, s53, s49
    v_mfma_f32_16x16x32_bf16 v[4:7], v[108:111], v[76:79], v[4:7]
    buffer_load_dwordx4 v[60:63], v253, s[36:39], s53 offen sc1
    v_mfma_f32_16x16x32_bf16 v[8:11], v[108:111], v[80:83], v[8:11]
    s_add_u32 s53, s53, 131072
    buffer_load_dwordx4 v[64:67], v253, s[36:39], s53 offen sc1
    v_mfma_f32_16x16x32_bf16 v[12:15], v[112:115], v[72:75], v[12:15]
    s_add_u32 s53, s53, 131072
    buffer_load_dwordx4 v[68:71], v253, s[36:39], s53 offen sc1
    v_mfma_f32_16x16x32_bf16 v[16:19], v[112:115], v[76:79], v[16:19]
    v_mfma_f32_16x16x32_bf16 v[20:23], v[112:115], v[80:83], v[20:23]
    v_mfma_f32_16x16x32_bf16 v[24:27], v[116:119], v[72:75], v[24:27]
    v_mfma_f32_16x16x32_bf16 v[28:31], v[116:119], v[76:79], v[28:31]
    v_mfma_f32_16x16x32_bf16 v[32:35], v[116:119], v[80:83], v[32:35]
    v_mfma_f32_16x16x32_bf16 v[36:39], v[120:123], v[72:75], v[36:39]
    v_mfma_f32_16x16x32_bf16 v[40:43], v[120:123], v[76:79], v[40:43]
    v_mfma_f32_16x16x32_bf16 v[44:47], v[120:123], v[80:83], v[44:47]
    v_add_u32 v135, s44, v253
    s_nop 6
    ds_write_b128 v135, v[0:3] offset:0
    ds_write_b128 v135, v[4:7] offset:1024
    ds_write_b128 v135, v[8:11] offset:2048
    ds_write_b128 v135, v[12:15] offset:3072
    ds_write_b128 v135, v[16:19] offset:4096
    ds_write_b128 v135, v[20:23] offset:5120
    ds_write_b128 v135, v[24:27] offset:6144
L_stub70:
    s_cbranch_execz L_dry_back
    ds_write_b128 v135, v[28:31] offset:7168
    ds_write_b128 v135, v[32:35] offset:8192
    ds_write_b128 v135, v[36:39] offset:9216
    ds_write_b128 v135, v[40:43] offset:10240
    ds_write_b128 v135, v[44:47] offset:11264
    v_lshlrev_b32 v129, 14, v255
    v_add_u32 v129, 98304, v129
    s_mov_b64 exec, 15
    ds_add_u32 v129, v134
    s_mov_b64 exec, -1
    s_setprio 1
    s_waitcnt vmcnt(9)
    v_mfma_f32_16x16x32_bf16 v[0:3], v[136:139], v[84:87], 0
    s_add_u32 s53, s63, 4
    s_and_b32 s53, s53, 7
    s_lshl_b32 s53, s53, 10
    s_add_u32 s53, s53, s49
    v_mfma_f32_16x16x32_bf16 v[4:7], v[136:139], v[88:91], 0
    buffer_load_dwordx4 v[72:75], v253, s[36:39], s53 offen sc1
    v_mfma_f32_16x16x32_bf16 v[8:11], v[136:139], v[92:95], 0
    s_add_u32 s53, s53, 131072
    buffer_load_dwordx4 v[76:79], v253, s[36:39], s53 offen sc1
    v_mfma_f32_16x16x32_bf16 v[12:15], v[140:143], v[84:87], 0
    s_add_u32 s53, s53, 131072
    buffer_load_dwordx4 v[80:83], v253, s[36:39], s53 offen sc1
    v_mfma_f32_16x16x32_bf16 v[16:19], v[140:143], v[88:91], 0
    v_mfma_f32_16x16x32_bf16 v[20:23], v[140:143], v[92:95], 0
    v_mfma_f32_16x16x32_bf16 v[24:27], v[144:147], v[84:87], 0
    v_mfma_f32_16x16x32_bf16 v[28:31], v[144:147], v[88:91], 0
    v_mfma_f32_16x16x32_bf16 v[32:35], v[144:147], v[92:95], 0
    v_mfma_f32_16x16x32_bf16 v[36:39], v[148:151], v[84:87], 0
    v_mfma_f32_16x16x32_bf16 v[40:43], v[148:151], v[88:91], 0
    v_mfma_f32_16x16x32_bf16 v[44:47], v[148:151], v[92:95], 0
    s_setprio 1
    s_waitcnt vmcnt(9)
    v_mfma_f32_16x16x32_bf16 v[0:3], v[152:155], v[96:99], v[0:3]
    s_add_u32 s53, s63, 5
    s_and_b32 s53, s53, 7
L_stub71:
    s_cbranch_execz L_dry_back
    s_lshl_b32 s53, s53, 10
    s_add_u32 s53, s53, s49
    v_mfma_f32_16x16x32_bf16 v[4:7], v[152:155], v[100:103], v[4:7]
    buffer_load_dwordx4 v[84:87], v253, s[36:39], s53 offen sc1
    v_mfma_f32_16x16x32_bf16 v[8:11], v[152:155], v[104:107], v[8:11]
    s_add_u32 s53, s53, 131072
    buffer_load_dwordx4 v[88:91], v253, s[36:39], s53 offen sc1
    v_mfma_f32_16x16x32_bf16 v[12:15], v[156:159], v[96:99], v[12:15]
    s_add_u32 s53, s53, 131072
    buffer_load_dwordx4 v[92:95], v253, s[36:39], s53 offen sc1
    v_mfma_f32_16x16x32_bf16 v[16:19], v[156:159], v[100:103], v[16:19]
    v_mfma_f32_16x16x32_bf16 v[20:23], v[156:159], v[104:107], v[20:23]
    v_mfma_f32_16x16x32_bf16 v[24:27], v[160:163], v[96:99], v[24:27]
    v_mfma_f32_16x16x32_bf16 v[28:31], v[160:163], v[100:103], v[28:31]
    v_mfma_f32_16x16x32_bf16 v[32:35], v[160:163], v[104:107], v[32:35]
    v_mfma_f32_16x16x32_bf16 v[36:39], v[164:167], v[96:99], v[36:39]
    v_mfma_f32_16x16x32_bf16 v[40:43], v[164:167], v[100:103], v[40:43]
    v_mfma_f32_16x16x32_bf16 v[44:47], v[164:167], v[104:107], v[44:47]
    s_setprio 1
    s_waitcnt vmcnt(9)
    v_mfma_f32_16x16x32_bf16 v[0:3], v[168:171], v[48:51], v[0:3]
    s_add_u32 s53, s63, 6
    s_and_b32 s53, s53, 7
    s_lshl_b32 s53, s53, 10
    s_add_u32 s53, s53, s49
    v_mfma_f32_16x16x32_bf16 v[4:7], v[168:171], v[52:55], v[4:7]
    buffer_load_dwordx4 v[96:99], v253, s[36:39], s53 offen sc1
    v_mfma_f32_16x16x32_bf16 v[8:11], v[168:171], v[56:59], v[8:11]
    s_add_u32 s53, s53, 131072
    buffer_load_dwordx4 v[100:103], v253, s[36:39], s53 offen sc1
    v_mfma_f32_16x16x32_bf16 v[12:15], v[172:175], v[48:51], v[12:15]
    s_add_u32 s53, s53, 131072
    buffer_load_dwordx4 v[104:107], v253, s[36:39], s53 offen sc1
    v_mfma_f32_16x16x32_bf16 v[16:19], v[172:175], v[52:55], v[16:19]
    v_mfma_f32_16x16x32_bf16 v[20:23], v[172:175], v[56:59], v[20:23]
    v_mfma_f32_16x16x32_bf16 v[24:27], v[176:179], v[48:51], v[24:27]
L_stub72:
    s_cbranch_execz L_dry_back
    v_mfma_f32_16x16x32_bf16 v[28:31], v[176:179], v[52:55], v[28:31]
    v_mfma_f32_16x16x32_bf16 v[32:35], v[176:179], v[56:59], v[32:35]
    v_mfma_f32_16x16x32_bf16 v[36:39], v[180:183], v[48:51], v[36:39]
    v_mfma_f32_16x16x32_bf16 v[40:43], v[180:183], v[52:55], v[40:43]
    v_mfma_f32_16x16x32_bf16 v[44:47], v[180:183], v[56:59], v[44:47]
    s_setprio 1
    s_waitcnt vmcnt(9)
    v_mfma_f32_16x16x32_bf16 v[0:3], v[184:187], v[60:63], v[0:3]
    s_add_u32 s53, s63, 7
    s_and_b32 s53, s53, 7
    s_lshl_b32 s53, s53, 10
    s_add_u32 s53, s53, s49
    v_mfma_f32_16x16x32_bf16 v[4:7], v[184:187], v[64:67], v[4:7]
    buffer_load_dwordx4 v[48:51], v253, s[36:39], s53 offen sc1
    v_mfma_f32_16x16x32_bf16 v[8:11], v[184:187], v[68:71], v[8:11]
    s_add_u32 s53, s53, 131072
    buffer_load_dwordx4 v[52:55], v253, s[36:39], s53 offen sc1
    v_mfma_f32_16x16x32_bf16 v[12:15], v[188:191], v[60:63], v[12:15]
    s_add_u32 s53, s53, 131072
    buffer_load_dwordx4 v[56:59], v253, s[36:39], s53 offen sc1
    v_mfma_f32_16x16x32_bf16 v[16:19], v[188:191], v[64:67], v[16:19]
    v_mfma_f32_16x16x32_bf16 v[20:23], v[188:191], v[68:71], v[20:23]
    v_mfma_f32_16x16x32_bf16 v[24:27], v[192:195], v[60:63], v[24:27]
    v_mfma_f32_16x16x32_bf16 v[28:31], v[192:195], v[64:67], v[28:31]
    v_mfma_f32_16x16x32_bf16 v[32:35], v[192:195], v[68:71], v[32:35]
    v_mfma_f32_16x16x32_bf16 v[36:39], v[196:199], v[60:63], v[36:39]
    v_mfma_f32_16x16x32_bf16 v[40:43], v[196:199], v[64:67], v[40:43]
    v_mfma_f32_16x16x32_bf16 v[44:47], v[196:199], v[68:71], v[44:47]
    s_setprio 0
    s_waitcnt vmcnt(9)
    v_mfma_f32_16x16x32_bf16 v[0:3], v[200:203], v[72:75], v[0:3]
    v_mfma_f32_16x16x32_bf16 v[4:7], v[200:203], v[76:79], v[4:7]
    v_mfma_f32_16x16x32_bf16 v[8:11], v[200:203], v[80:83], v[8:11]
    v_mfma_f32_16x16x32_bf16 v[12:15], v[204:207], v[72:75], v[12:15]
    v_mfma_f32_16x16x32_bf16 v[16:19], v[204:207], v[76:79], v[16:19]
L_stub73:
    s_cbranch_execz L_dry_back
    v_mfma_f32_16x16x32_bf16 v[20:23], v[204:207], v[80:83], v[20:23]
    v_mfma_f32_16x16x32_bf16 v[24:27], v[208:211], v[72:75], v[24:27]
    v_mfma_f32_16x16x32_bf16 v[28:31], v[208:211], v[76:79], v[28:31]
    v_mfma_f32_16x16x32_bf16 v[32:35], v[208:211], v[80:83], v[32:35]
    v_mfma_f32_16x16x32_bf16 v[36:39], v[212:215], v[72:75], v[36:39]
    v_mfma_f32_16x16x32_bf16 v[40:43], v[212:215], v[76:79], v[40:43]
    v_mfma_f32_16x16x32_bf16 v[44:47], v[212:215], v[80:83], v[44:47]
    s_setprio 0
    s_waitcnt vmcnt(6)
    v_mfma_f32_16x16x32_bf16 v[0:3], v[216:219], v[84:87], v[0:3]
    v_mfma_f32_16x16x32_bf16 v[4:7], v[216:219], v[88:91], v[4:7]
    v_mfma_f32_16x16x32_bf16 v[8:11], v[216:219], v[92:95], v[8:11]
    v_mfma_f32_16x16x32_bf16 v[12:15], v[220:223], v[84:87], v[12:15]
    v_mfma_f32_16x16x32_bf16 v[16:19], v[220:223], v[88:91], v[16:19]
    v_mfma_f32_16x16x32_bf16 v[20:23], v[220:223], v[92:95], v[20:23]
    v_mfma_f32_16x16x32_bf16 v[24:27], v[224:227], v[84:87], v[24:27]
    v_mfma_f32_16x16x32_bf16 v[28:31], v[224:227], v[88:91], v[28:31]
    v_mfma_f32_16x16x32_bf16 v[32:35], v[224:227], v[92:95], v[32:35]
    v_mfma_f32_16x16x32_bf16 v[36:39], v[228:231], v[84:87], v[36:39]
    v_mfma_f32_16x16x32_bf16 v[40:43], v[228:231], v[88:91], v[40:43]
    v_mfma_f32_16x16x32_bf16 v[44:47], v[228:231], v[92:95], v[44:47]
    s_setprio 0
    s_waitcnt vmcnt(3)
    v_mfma_f32_16x16x32_bf16 v[0:3], v[232:235], v[96:99], v[0:3]
    v_mfma_f32_16x16x32_bf16 v[4:7], v[232:235], v[100:103], v[4:7]
    v_mfma_f32_16x16x32_bf16 v[8:11], v[232:235], v[104:107], v[8:11]
    v_mfma_f32_16x16x32_bf16 v[12:15], v[236:239], v[96:99], v[12:15]
    v_mfma_f32_16x16x32_bf16 v[16:19], v[236:239], v[100:103], v[16:19]
    v_mfma_f32_16x16x32_bf16 v[20:23], v[236:239], v[104:107], v[20:23]
    v_mfma_f32_16x16x32_bf16 v[24:27], v[240:243], v[96:99], v[24:27]
    v_mfma_f32_16x16x32_bf16 v[28:31], v[240:243], v[100:103], v[28:31]
    v_mfma_f32_16x16x32_bf16 v[32:35], v[240:243], v[104:107], v[32:35]
    v_mfma_f32_16x16x32_bf16 v[36:39], v[244:247], v[96:99], v[36:39]
    v_mfma_f32_16x16x32_bf16 v[40:43], v[244:247], v[100:103], v[40:43]
L_stub74:
    s_cbranch_execz L_dry_back
    v_mfma_f32_16x16x32_bf16 v[44:47], v[244:247], v[104:107], v[44:47]
    s_setprio 0
    s_waitcnt vmcnt(0)
    v_mfma_f32_16x16x32_bf16 v[0:3], v[108:111], v[48:51], v[0:3]
    v_mfma_f32_16x16x32_bf16 v[4:7], v[108:111], v[52:55], v[4:7]
    v_mfma_f32_16x16x32_bf16 v[8:11], v[108:111], v[56:59], v[8:11]
    v_mfma_f32_16x16x32_bf16 v[12:15], v[112:115], v[48:51], v[12:15]
    v_mfma_f32_16x16x32_bf16 v[16:19], v[112:115], v[52:55], v[16:19]
    v_mfma_f32_16x16x32_bf16 v[20:23], v[112:115], v[56:59], v[20:23]
    v_mfma_f32_16x16x32_bf16 v[24:27], v[116:119], v[48:51], v[24:27]
    v_mfma_f32_16x16x32_bf16 v[28:31], v[116:119], v[52:55], v[28:31]
    v_mfma_f32_16x16x32_bf16 v[32:35], v[116:119], v[56:59], v[32:35]
    v_mfma_f32_16x16x32_bf16 v[36:39], v[120:123], v[48:51], v[36:39]
    v_mfma_f32_16x16x32_bf16 v[40:43], v[120:123], v[52:55], v[40:43]
    v_mfma_f32_16x16x32_bf16 v[44:47], v[120:123], v[56:59], v[44:47]
    s_lshl_b32 s46, s59, 14
    s_add_u32 s46, s46, 106496
    s_branch L_tail_fin
L_tail_m:
    s_lshr_b32 s43, s2, 3
    s_min_u32 s43, s43, 29
    s_mul_i32 s60, s43, 52
    s_lshr_b32 s60, s60, 8
    s_mul_i32 s61, s60, 5
    s_sub_u32 s61, s43, s61
    s_mov_b32 s63, 0
    s_and_b32 s43, s2, 4
    s_add_u32 s63, s63, s43
    s_and_b32 s63, s63, 7
    s_bfe_u32 s43, s2, 0x10002
    s_mul_i32 s43, s43, 6
    s_add_u32 s60, s60, s43
    s_bfe_u32 s43, s2, 0x10001
    s_mul_i32 s43, s43, 5
    s_add_u32 s61, s61, s43
    s_and_b32 s58, s2, 1
    s_mov_b32 s20, s12
    s_mov_b32 s21, s13
    s_mov_b32 s22, 5242880
    s_mov_b32 s23, 0x20000
    v_lshrrev_b32 v48, 3, v255
    v_mul_u32_u24 v48, 1280, v48
    v_lshrrev_b32 v49, 4, v255
    v_lshlrev_b32 v49, 1, v49
L_stub75:
    s_cbranch_execz L_dry_back
    v_and_b32 v50, 7, v255
    v_xor_b32 v49, v49, v50
    v_lshl_add_u32 v252, v49, 4, v48
    s_mul_i32 s44, s40, 12288
    s_add_u32 s44, s44, 49152
    s_lshl_b32 s46, s40, 14
    s_add_u32 s46, s46, 98304
    s_lshl_b32 s43, s58, 3
    s_add_u32 s43, s43, s40
    s_mul_i32 s47, s43, 327680
    s_lshl_b32 s43, s61, 7
    s_add_u32 s47, s47, s43
    v_mov_b32 v254, 0
    v_mov_b32 v134, 1
    s_lshr_b32 s43, s2, 3
    s_cmp_lt_u32 s43, 30
    s_cbranch_scc1 L_act_m
    s_lshl_b32 s43, s2, 4
    s_lshr_b32 s45, s2, 2
    s_lshl_b32 s45, s45, 7
    s_and_b32 s43, s43, 48
    s_add_u32 s45, s45, s43
    s_lshl_b32 s43, s40, 2
    s_add_u32 s45, s45, s43
    s_add_u32 s45, s45, 12582912
    s_mov_b64 exec, 1
    s_waitcnt vmcnt(0)
    buffer_store_dword v134, v254, s[36:39], s45 offen sc1
    s_mov_b64 exec, -1
    s_barrier
    s_branch L_fin
L_act_m:
    v_bfe_u32 v48, v255, 2, 2
    v_and_b32 v49, 3, v255
    v_bfe_u32 v50, v255, 4, 1
    v_lshrrev_b32 v52, 4, v255
    v_lshl_add_u32 v53, v52, 2, v48
    v_lshlrev_b32 v53, 7, v53
    v_and_b32 v54, 1, v49
    v_lshl_add_u32 v53, v54, 3, v53
    v_add_u32 v53, s44, v53
    v_and_b32 v54, 2, v48
    v_lshl_add_u32 v54, v50, 2, v54
    v_lshrrev_b32 v55, 1, v49
    v_or_b32 v54, v54, v55
    v_xor_b32 v55, 0, v54
    v_lshl_add_u32 v248, v55, 4, v53
    v_xor_b32 v55, 2, v54
    v_lshl_add_u32 v249, v55, 4, v53
    v_xor_b32 v55, 4, v54
L_stub76:
    s_cbranch_execz L_dry_back
    v_lshl_add_u32 v250, v55, 4, v53
    v_xor_b32 v55, 6, v54
    v_lshl_add_u32 v251, v55, 4, v53
    s_sub_u32 s43, s46, s44
    v_add_u32 v128, s43, v248
    v_add_u32 v129, s43, v249
    v_add_u32 v130, s43, v250
    v_add_u32 v131, s43, v251
    ds_read_b64_tr_b16 v[136:137], v128 offset:0
    ds_read_b64_tr_b16 v[138:139], v128 offset:2048
    ds_read_b64_tr_b16 v[140:141], v129 offset:0
    ds_read_b64_tr_b16 v[142:143], v129 offset:2048
    ds_read_b64_tr_b16 v[144:145], v130 offset:0
    ds_read_b64_tr_b16 v[146:147], v130 offset:2048
    ds_read_b64_tr_b16 v[148:149], v131 offset:0
    ds_read_b64_tr_b16 v[150:151], v131 offset:2048
    ds_read_b64_tr_b16 v[152:153], v128 offset:4096
    ds_read_b64_tr_b16 v[154:155], v128 offset:6144
    ds_read_b64_tr_b16 v[156:157], v129 offset:4096
    ds_read_b64_tr_b16 v[158:159], v129 offset:6144
    ds_read_b64_tr_b16 v[160:161], v130 offset:4096
    ds_read_b64_tr_b16 v[162:163], v130 offset:6144
    ds_read_b64_tr_b16 v[164:165], v131 offset:4096
    s_waitcnt lgkmcnt(14)
    ds_read_b64_tr_b16 v[166:167], v131 offset:6144
    s_waitcnt lgkmcnt(14)
    ds_read_b64_tr_b16 v[168:169], v128 offset:8192
    s_waitcnt lgkmcnt(14)
    ds_read_b64_tr_b16 v[170:171], v128 offset:10240
    s_waitcnt lgkmcnt(14)
    ds_read_b64_tr_b16 v[172:173], v129 offset:8192
    s_waitcnt lgkmcnt(14)
    ds_read_b64_tr_b16 v[174:175], v129 offset:10240
    s_waitcnt lgkmcnt(14)
    ds_read_b64_tr_b16 v[176:177], v130 offset:8192
    s_waitcnt lgkmcnt(14)
    ds_read_b64_tr_b16 v[178:179], v130 offset:10240
    s_waitcnt lgkmcnt(14)
    ds_read_b64_tr_b16 v[180:181], v131 offset:8192
L_stub77:
    s_cbranch_execz L_dry_back
    s_waitcnt lgkmcnt(14)
    ds_read_b64_tr_b16 v[182:183], v131 offset:10240
    s_waitcnt lgkmcnt(14)
    ds_read_b64_tr_b16 v[184:185], v128 offset:12288
    s_waitcnt lgkmcnt(14)
    ds_read_b64_tr_b16 v[186:187], v128 offset:14336
    s_waitcnt lgkmcnt(14)
    ds_read_b64_tr_b16 v[188:189], v129 offset:12288
    s_waitcnt lgkmcnt(14)
    ds_read_b64_tr_b16 v[190:191], v129 offset:14336
    s_waitcnt lgkmcnt(14)
    ds_read_b64_tr_b16 v[192:193], v130 offset:12288
    s_waitcnt lgkmcnt(14)
    ds_read_b64_tr_b16 v[194:195], v130 offset:14336
    s_waitcnt lgkmcnt(14)
    ds_read_b64_tr_b16 v[196:197], v131 offset:12288
    s_waitcnt lgkmcnt(14)
    ds_read_b64_tr_b16 v[198:199], v131 offset:14336
    s_lshl_b32 s43, s40, 12
    s_add_u32 s43, s43, 32768
    s_sub_u32 s43, s43, s46
    v_add_u32 v128, s43, v128
    v_add_u32 v129, s43, v129
    v_add_u32 v130, s43, v130
    v_add_u32 v131, s43, v131
    s_waitcnt lgkmcnt(14)
    ds_read_b64_tr_b16 v[200:201], v128 offset:0
    s_waitcnt lgkmcnt(14)
    ds_read_b64_tr_b16 v[202:203], v128 offset:2048
    s_waitcnt lgkmcnt(14)
    ds_read_b64_tr_b16 v[204:205], v129 offset:0
    s_waitcnt lgkmcnt(14)
    ds_read_b64_tr_b16 v[206:207], v129 offset:2048
    s_waitcnt lgkmcnt(14)
    ds_read_b64_tr_b16 v[208:209], v130 offset:0
    s_waitcnt lgkmcnt(14)
    ds_read_b64_tr_b16 v[210:211], v130 offset:2048
    s_waitcnt lgkmcnt(14)
    ds_read_b64_tr_b16 v[212:213], v131 offset:0
    s_waitcnt lgkmcnt(14)
    ds_read_b64_tr_b16 v[214:215], v131 offset:2048
    s_waitcnt lgkmcnt(0)
    v_mov_b32 v128, s46
    ds_write_b32 v128, v254
L_stub78:
    s_cbranch_execz L_dry_back
    s_waitcnt lgkmcnt(0)
    s_lshl_b32 s43, s2, 4
    s_lshr_b32 s45, s2, 2
    s_lshl_b32 s45, s45, 7
    s_and_b32 s43, s43, 48
    s_add_u32 s45, s45, s43
    s_lshl_b32 s43, s40, 2
    s_add_u32 s45, s45, s43
    s_add_u32 s45, s45, 12582912
    s_mov_b64 exec, 1
    s_waitcnt vmcnt(0)
    buffer_store_dword v134, v254, s[36:39], s45 offen sc1
    s_mov_b64 exec, -1
    s_barrier
    s_add_u32 s52, s63, 5
    s_and_b32 s52, s52, 7
    s_mul_i32 s52, s52, 40960
    s_add_u32 s52, s52, s47
    s_add_u32 m0, s44, 0
    s_add_u32 s55, s52, 0
    buffer_load_dwordx4 v252, s[20:23], s55 offen lds
    s_add_u32 m0, s44, 1024
    s_add_u32 s55, s52, 10240
    buffer_load_dwordx4 v252, s[20:23], s55 offen lds
    s_add_u32 m0, s44, 2048
    s_add_u32 s55, s52, 20480
    buffer_load_dwordx4 v252, s[20:23], s55 offen lds
    s_add_u32 m0, s44, 3072
    s_add_u32 s55, s52, 30720
    buffer_load_dwordx4 v252, s[20:23], s55 offen lds
    s_add_u32 s52, s63, 6
    s_and_b32 s52, s52, 7
    s_mul_i32 s52, s52, 40960
    s_add_u32 s52, s52, s47
    s_add_u32 m0, s44, 4096
    s_add_u32 s55, s52, 0
    buffer_load_dwordx4 v252, s[20:23], s55 offen lds
    s_add_u32 m0, s44, 5120
    s_add_u32 s55, s52, 10240
    buffer_load_dwordx4 v252, s[20:23], s55 offen lds
    s_add_u32 m0, s44, 6144
    s_add_u32 s55, s52, 20480
L_stub79:
    s_cbranch_execz L_dry_back
    buffer_load_dwordx4 v252, s[20:23], s55 offen lds
    s_add_u32 m0, s44, 7168
    s_add_u32 s55, s52, 30720
    buffer_load_dwordx4 v252, s[20:23], s55 offen lds
    s_add_u32 s52, s63, 7
    s_and_b32 s52, s52, 7
    s_mul_i32 s52, s52, 40960
    s_add_u32 s52, s52, s47
    s_add_u32 m0, s44, 8192
    s_add_u32 s55, s52, 0
    buffer_load_dwordx4 v252, s[20:23], s55 offen lds
    s_add_u32 m0, s44, 9216
    s_add_u32 s55, s52, 10240
    buffer_load_dwordx4 v252, s[20:23], s55 offen lds
    s_add_u32 m0, s44, 10240
    s_add_u32 s55, s52, 20480
    buffer_load_dwordx4 v252, s[20:23], s55 offen lds
    s_add_u32 m0, s44, 11264
    s_add_u32 s55, s52, 30720
    buffer_load_dwordx4 v252, s[20:23], s55 offen lds
    s_mov_b32 s43, s58
    s_lshl_b32 s50, s60, 1
    s_add_u32 s51, s50, s43
    s_add_u32 s50, s50, 1
    s_sub_u32 s50, s50, s43
    s_lshl_b32 s43, s58, 3
    s_add_u32 s43, s43, s40
    s_lshl_b32 s43, s43, 13
    s_mul_i32 s48, s50, 393216
    s_add_u32 s48, s48, s43
    s_mul_i32 s49, s51, 393216
    s_add_u32 s49, s49, s43
    s_lshl_b32 s43, s58, 2
    s_lshr_b32 s45, s40, 1
    s_add_u32 s43, s43, s45
    s_lshl_b32 s43, s43, 7
    s_add_u32 s43, s43, 12582912
    s_mul_i32 s56, s50, 43
    s_lshr_b32 s56, s56, 7
    s_lshl_b32 s56, s56, 10
    s_add_u32 s56, s56, s43
    s_mul_i32 s57, s51, 43
    s_lshr_b32 s57, s57, 7
L_stub80:
    s_cbranch_execz L_dry_back
    s_lshl_b32 s57, s57, 10
    s_add_u32 s57, s57, s43
    v_and_b32 v132, 7, v255
    s_and_b32 s43, s40, 1
    s_lshl_b32 s43, s43, 5
    v_lshl_add_u32 v132, v132, 2, s43
    v_lshlrev_b32 v253, 4, v255
    buffer_load_dword v133, v132, s[36:39], s56 offen sc1
    v_mov_b32 v0, 0
    v_mov_b32 v1, 0
    v_mov_b32 v2, 0
    v_mov_b32 v3, 0
    v_mov_b32 v4, 0
    v_mov_b32 v5, 0
    v_mov_b32 v6, 0
    v_mov_b32 v7, 0
    v_mov_b32 v8, 0
    v_mov_b32 v9, 0
    v_mov_b32 v10, 0
    v_mov_b32 v11, 0
    v_mov_b32 v12, 0
    v_mov_b32 v13, 0
    v_mov_b32 v14, 0
    v_mov_b32 v15, 0
    v_mov_b32 v16, 0
    v_mov_b32 v17, 0
    v_mov_b32 v18, 0
    v_mov_b32 v19, 0
    v_mov_b32 v20, 0
    v_mov_b32 v21, 0
    v_mov_b32 v22, 0
    v_mov_b32 v23, 0
    v_mov_b32 v24, 0
    v_mov_b32 v25, 0
    v_mov_b32 v26, 0
    v_mov_b32 v27, 0
    v_mov_b32 v28, 0
    v_mov_b32 v29, 0
    v_mov_b32 v30, 0
    v_mov_b32 v31, 0
    v_mov_b32 v32, 0
    v_mov_b32 v33, 0
    v_mov_b32 v34, 0
    v_mov_b32 v35, 0
    v_mov_b32 v36, 0
    v_mov_b32 v37, 0
    v_mov_b32 v38, 0
    v_mov_b32 v39, 0
    v_mov_b32 v40, 0
    v_mov_b32 v41, 0
    v_mov_b32 v42, 0
    v_mov_b32 v43, 0
    v_mov_b32 v44, 0
    v_mov_b32 v45, 0
    v_mov_b32 v46, 0
    v_mov_b32 v47, 0
    s_waitcnt vmcnt(0)
    s_mov_b32 s53, 0
L_poll_m0:
    v_cmp_ne_u32 vcc, 1, v133
    s_cbranch_vccz L_polled_m0
    s_sleep 8
L_stub81:
    s_cbranch_execz L_dry_back
    buffer_load_dword v133, v132, s[36:39], s56 offen sc1
    s_add_u32 s53, s53, 1
    s_waitcnt vmcnt(0)
    s_cmp_lt_u32 s53, 0x40000
    s_cbranch_scc1 L_poll_m0
L_polled_m0:
    buffer_load_dword v133, v132, s[36:39], s57 offen sc1
    s_add_u32 s53, s63, 0
    s_and_b32 s53, s53, 7
    s_lshl_b32 s53, s53, 10
    s_add_u32 s53, s53, s48
    buffer_load_dwordx4 v[48:51], v253, s[36:39], s53 offen sc1
    s_add_u32 s53, s53, 131072
    buffer_load_dwordx4 v[52:55], v253, s[36:39], s53 offen sc1
    s_add_u32 s53, s53, 131072
    buffer_load_dwordx4 v[56:59], v253, s[36:39], s53 offen sc1
    s_add_u32 s53, s63, 1
    s_and_b32 s53, s53, 7
    s_lshl_b32 s53, s53, 10
    s_add_u32 s53, s53, s48
    buffer_load_dwordx4 v[60:63], v253, s[36:39], s53 offen sc1
    s_add_u32 s53, s53, 131072
    buffer_load_dwordx4 v[64:67], v253, s[36:39], s53 offen sc1
    s_add_u32 s53, s53, 131072
    buffer_load_dwordx4 v[68:71], v253, s[36:39], s53 offen sc1
    s_add_u32 s53, s63, 2
    s_and_b32 s53, s53, 7
    s_lshl_b32 s53, s53, 10
    s_add_u32 s53, s53, s48
    buffer_load_dwordx4 v[72:75], v253, s[36:39], s53 offen sc1
    s_add_u32 s53, s53, 131072
    buffer_load_dwordx4 v[76:79], v253, s[36:39], s53 offen sc1
    s_add_u32 s53, s53, 131072
    buffer_load_dwordx4 v[80:83], v253, s[36:39], s53 offen sc1
    s_add_u32 s53, s63, 3
    s_and_b32 s53, s53, 7
    s_lshl_b32 s53, s53, 10
    s_add_u32 s53, s53, s48
    buffer_load_dwordx4 v[84:87], v253, s[36:39], s53 offen sc1
    s_add_u32 s53, s53, 131072
    buffer_load_dwordx4 v[88:91], v253, s[36:39], s53 offen sc1
    s_add_u32 s53, s53, 131072
L_stub82:
    s_cbranch_execz L_dry_back
    buffer_load_dwordx4 v[92:95], v253, s[36:39], s53 offen sc1
    s_setprio 3
    s_waitcnt vmcnt(9)
    v_mfma_f32_16x16x32_bf16 v[0:3], v[136:139], v[48:51], v[0:3]
    s_add_u32 s53, s63, 4
    s_and_b32 s53, s53, 7
    s_lshl_b32 s53, s53, 10
    s_add_u32 s53, s53, s48
    v_mfma_f32_16x16x32_bf16 v[4:7], v[136:139], v[52:55], v[4:7]
    buffer_load_dwordx4 v[96:99], v253, s[36:39], s53 offen sc1
    v_mfma_f32_16x16x32_bf16 v[8:11], v[136:139], v[56:59], v[8:11]
    s_add_u32 s53, s53, 131072
    buffer_load_dwordx4 v[100:103], v253, s[36:39], s53 offen sc1
    v_mfma_f32_16x16x32_bf16 v[12:15], v[140:143], v[48:51], v[12:15]
    s_add_u32 s53, s53, 131072
    buffer_load_dwordx4 v[104:107], v253, s[36:39], s53 offen sc1
    v_mfma_f32_16x16x32_bf16 v[16:19], v[140:143], v[52:55], v[16:19]
    v_mfma_f32_16x16x32_bf16 v[20:23], v[140:143], v[56:59], v[20:23]
    v_mfma_f32_16x16x32_bf16 v[24:27], v[144:147], v[48:51], v[24:27]
    v_mfma_f32_16x16x32_bf16 v[28:31], v[144:147], v[52:55], v[28:31]
    v_mfma_f32_16x16x32_bf16 v[32:35], v[144:147], v[56:59], v[32:35]
    v_mfma_f32_16x16x32_bf16 v[36:39], v[148:151], v[48:51], v[36:39]
    v_mfma_f32_16x16x32_bf16 v[40:43], v[148:151], v[52:55], v[40:43]
    v_mfma_f32_16x16x32_bf16 v[44:47], v[148:151], v[56:59], v[44:47]
    s_setprio 3
    s_waitcnt vmcnt(9)
    v_mfma_f32_16x16x32_bf16 v[0:3], v[152:155], v[60:63], v[0:3]
    s_add_u32 s53, s63, 5
    s_and_b32 s53, s53, 7
    s_lshl_b32 s53, s53, 10
    s_add_u32 s53, s53, s48
    v_mfma_f32_16x16x32_bf16 v[4:7], v[152:155], v[64:67], v[4:7]
    buffer_load_dwordx4 v[48:51], v253, s[36:39], s53 offen sc1
    v_mfma_f32_16x16x32_bf16 v[8:11], v[152:155], v[68:71], v[8:11]
    s_add_u32 s53, s53, 131072
    buffer_load_dwordx4 v[52:55], v253, s[36:39], s53 offen sc1
    v_mfma_f32_16x16x32_bf16 v[12:15], v[156:159], v[60:63], v[12:15]
    s_add_u32 s53, s53, 131072
L_stub83:
    s_cbranch_execz L_dry_back
    buffer_load_dwordx4 v[56:59], v253, s[36:39], s53 offen sc1
    v_mfma_f32_16x16x32_bf16 v[16:19], v[156:159], v[64:67], v[16:19]
    ds_read_b64_tr_b16 v[216:217], v248 offset:0
    ds_read_b64_tr_b16 v[218:219], v248 offset:2048
    ds_read_b64_tr_b16 v[220:221], v249 offset:0
    ds_read_b64_tr_b16 v[222:223], v249 offset:2048
    ds_read_b64_tr_b16 v[224:225], v250 offset:0
    ds_read_b64_tr_b16 v[226:227], v250 offset:2048
    ds_read_b64_tr_b16 v[228:229], v251 offset:0
    ds_read_b64_tr_b16 v[230:231], v251 offset:2048
    v_mfma_f32_16x16x32_bf16 v[20:23], v[156:159], v[68:71], v[20:23]
    v_mfma_f32_16x16x32_bf16 v[24:27], v[160:163], v[60:63], v[24:27]
    v_mfma_f32_16x16x32_bf16 v[28:31], v[160:163], v[64:67], v[28:31]
    v_mfma_f32_16x16x32_bf16 v[32:35], v[160:163], v[68:71], v[32:35]
    v_mfma_f32_16x16x32_bf16 v[36:39], v[164:167], v[60:63], v[36:39]
    v_mfma_f32_16x16x32_bf16 v[40:43], v[164:167], v[64:67], v[40:43]
    v_mfma_f32_16x16x32_bf16 v[44:47], v[164:167], v[68:71], v[44:47]
    s_setprio 3
    s_waitcnt vmcnt(9)
    v_mfma_f32_16x16x32_bf16 v[0:3], v[168:171], v[72:75], v[0:3]
    s_add_u32 s53, s63, 6
    s_and_b32 s53, s53, 7
    s_lshl_b32 s53, s53, 10
    s_add_u32 s53, s53, s48
    v_mfma_f32_16x16x32_bf16 v[4:7], v[168:171], v[76:79], v[4:7]
    buffer_load_dwordx4 v[60:63], v253, s[36:39], s53 offen sc1
    v_mfma_f32_16x16x32_bf16 v[8:11], v[168:171], v[80:83], v[8:11]
    s_add_u32 s53, s53, 131072
    buffer_load_dwordx4 v[64:67], v253, s[36:39], s53 offen sc1
    v_mfma_f32_16x16x32_bf16 v[12:15], v[172:175], v[72:75], v[12:15]
    s_add_u32 s53, s53, 131072
    buffer_load_dwordx4 v[68:71], v253, s[36:39], s53 offen sc1
    v_mfma_f32_16x16x32_bf16 v[16:19], v[172:175], v[76:79], v[16:19]
    ds_read_b64_tr_b16 v[232:233], v248 offset:4096
L_stub84:
    s_cbranch_execz L_dry_back
    ds_read_b64_tr_b16 v[234:235], v248 offset:6144
    ds_read_b64_tr_b16 v[236:237], v249 offset:4096
    ds_read_b64_tr_b16 v[238:239], v249 offset:6144
    ds_read_b64_tr_b16 v[240:241], v250 offset:4096
    ds_read_b64_tr_b16 v[242:243], v250 offset:6144
    ds_read_b64_tr_b16 v[244:245], v251 offset:4096
    s_waitcnt lgkmcnt(14)
    ds_read_b64_tr_b16 v[246:247], v251 offset:6144
    v_mfma_f32_16x16x32_bf16 v[20:23], v[172:175], v[80:83], v[20:23]
    v_mfma_f32_16x16x32_bf16 v[24:27], v[176:179], v[72:75], v[24:27]
    v_mfma_f32_16x16x32_bf16 v[28:31], v[176:179], v[76:79], v[28:31]
    v_mfma_f32_16x16x32_bf16 v[32:35], v[176:179], v[80:83], v[32:35]
    v_mfma_f32_16x16x32_bf16 v[36:39], v[180:183], v[72:75], v[36:39]
    v_mfma_f32_16x16x32_bf16 v[40:43], v[180:183], v[76:79], v[40:43]
    v_mfma_f32_16x16x32_bf16 v[44:47], v[180:183], v[80:83], v[44:47]
    s_setprio 3
    s_waitcnt vmcnt(9)
    v_mfma_f32_16x16x32_bf16 v[0:3], v[184:187], v[84:87], v[0:3]
    s_add_u32 s53, s63, 7
    s_and_b32 s53, s53, 7
    s_lshl_b32 s53, s53, 10
    s_add_u32 s53, s53, s48
    v_mfma_f32_16x16x32_bf16 v[4:7], v[184:187], v[88:91], v[4:7]
    buffer_load_dwordx4 v[72:75], v253, s[36:39], s53 offen sc1
    v_mfma_f32_16x16x32_bf16 v[8:11], v[184:187], v[92:95], v[8:11]
    s_add_u32 s53, s53, 131072
    buffer_load_dwordx4 v[76:79], v253, s[36:39], s53 offen sc1
    v_mfma_f32_16x16x32_bf16 v[12:15], v[188:191], v[84:87], v[12:15]
    s_add_u32 s53, s53, 131072
    buffer_load_dwordx4 v[80:83], v253, s[36:39], s53 offen sc1
    v_mfma_f32_16x16x32_bf16 v[16:19], v[188:191], v[88:91], v[16:19]
    s_waitcnt lgkmcnt(14)
    ds_read_b64_tr_b16 v[108:109], v248 offset:8192
    s_waitcnt lgkmcnt(14)
    ds_read_b64_tr_b16 v[110:111], v248 offset:10240
    s_waitcnt lgkmcnt(14)
    ds_read_b64_tr_b16 v[112:113], v249 offset:8192
L_stub85:
    s_cbranch_execz L_dry_back
    s_waitcnt lgkmcnt(14)
    ds_read_b64_tr_b16 v[114:115], v249 offset:10240
    s_waitcnt lgkmcnt(14)
    ds_read_b64_tr_b16 v[116:117], v250 offset:8192
    s_waitcnt lgkmcnt(14)
    ds_read_b64_tr_b16 v[118:119], v250 offset:10240
    s_waitcnt lgkmcnt(14)
    ds_read_b64_tr_b16 v[120:121], v251 offset:8192
    s_waitcnt lgkmcnt(14)
    ds_read_b64_tr_b16 v[122:123], v251 offset:10240
    v_mfma_f32_16x16x32_bf16 v[20:23], v[188:191], v[92:95], v[20:23]
    v_mfma_f32_16x16x32_bf16 v[24:27], v[192:195], v[84:87], v[24:27]
    v_mfma_f32_16x16x32_bf16 v[28:31], v[192:195], v[88:91], v[28:31]
    v_mfma_f32_16x16x32_bf16 v[32:35], v[192:195], v[92:95], v[32:35]
    v_mfma_f32_16x16x32_bf16 v[36:39], v[196:199], v[84:87], v[36:39]
    v_mfma_f32_16x16x32_bf16 v[40:43], v[196:199], v[88:91], v[40:43]
    v_mfma_f32_16x16x32_bf16 v[44:47], v[196:199], v[92:95], v[44:47]
    s_setprio 2
    s_waitcnt vmcnt(9)
    v_mfma_f32_16x16x32_bf16 v[0:3], v[200:203], v[96:99], v[0:3]
    s_mov_b32 s53, 0
L_poll_m1:
    v_cmp_ne_u32 vcc, 1, v133
    s_cbranch_vccz L_polled_m1
    s_sleep 8
    buffer_load_dword v133, v132, s[36:39], s57 offen sc1
    s_add_u32 s53, s53, 1
    s_waitcnt vmcnt(0)
    s_cmp_lt_u32 s53, 0x40000
    s_cbranch_scc1 L_poll_m1
L_polled_m1:
    v_mfma_f32_16x16x32_bf16 v[4:7], v[200:203], v[100:103], v[4:7]
    s_add_u32 s53, s63, 0
    s_and_b32 s53, s53, 7
    s_lshl_b32 s53, s53, 10
    s_add_u32 s53, s53, s49
    v_mfma_f32_16x16x32_bf16 v[8:11], v[200:203], v[104:107], v[8:11]
    buffer_load_dwordx4 v[84:87], v253, s[36:39], s53 offen sc1
    v_mfma_f32_16x16x32_bf16 v[12:15], v[204:207], v[96:99], v[12:15]
    s_add_u32 s53, s53, 131072
    buffer_load_dwordx4 v[88:91], v253, s[36:39], s53 offen sc1
    v_mfma_f32_16x16x32_bf16 v[16:19], v[204:207], v[100:103], v[16:19]
L_stub86:
    s_cbranch_execz L_dry_back
    s_add_u32 s53, s53, 131072
    buffer_load_dwordx4 v[92:95], v253, s[36:39], s53 offen sc1
    v_mfma_f32_16x16x32_bf16 v[20:23], v[204:207], v[104:107], v[20:23]
    v_mfma_f32_16x16x32_bf16 v[24:27], v[208:211], v[96:99], v[24:27]
    v_mfma_f32_16x16x32_bf16 v[28:31], v[208:211], v[100:103], v[28:31]
    v_mfma_f32_16x16x32_bf16 v[32:35], v[208:211], v[104:107], v[32:35]
    v_mfma_f32_16x16x32_bf16 v[36:39], v[212:215], v[96:99], v[36:39]
    v_mfma_f32_16x16x32_bf16 v[40:43], v[212:215], v[100:103], v[40:43]
    v_mfma_f32_16x16x32_bf16 v[44:47], v[212:215], v[104:107], v[44:47]
    s_setprio 2
    s_waitcnt vmcnt(9)
    v_mfma_f32_16x16x32_bf16 v[0:3], v[216:219], v[48:51], v[0:3]
    s_add_u32 s53, s63, 1
    s_and_b32 s53, s53, 7
    s_lshl_b32 s53, s53, 10
    s_add_u32 s53, s53, s49
    v_mfma_f32_16x16x32_bf16 v[4:7], v[216:219], v[52:55], v[4:7]
    buffer_load_dwordx4 v[96:99], v253, s[36:39], s53 offen sc1
    v_mfma_f32_16x16x32_bf16 v[8:11], v[216:219], v[56:59], v[8:11]
    s_add_u32 s53, s53, 131072
    buffer_load_dwordx4 v[100:103], v253, s[36:39], s53 offen sc1
    v_mfma_f32_16x16x32_bf16 v[12:15], v[220:223], v[48:51], v[12:15]
    s_add_u32 s53, s53, 131072
    buffer_load_dwordx4 v[104:107], v253, s[36:39], s53 offen sc1
    v_mfma_f32_16x16x32_bf16 v[16:19], v[220:223], v[52:55], v[16:19]
    v_mfma_f32_16x16x32_bf16 v[20:23], v[220:223], v[56:59], v[20:23]
    v_mfma_f32_16x16x32_bf16 v[24:27], v[224:227], v[48:51], v[24:27]
    v_mfma_f32_16x16x32_bf16 v[28:31], v[224:227], v[52:55], v[28:31]
    v_mfma_f32_16x16x32_bf16 v[32:35], v[224:227], v[56:59], v[32:35]
    v_mfma_f32_16x16x32_bf16 v[36:39], v[228:231], v[48:51], v[36:39]
    v_mfma_f32_16x16x32_bf16 v[40:43], v[228:231], v[52:55], v[40:43]
    v_mfma_f32_16x16x32_bf16 v[44:47], v[228:231], v[56:59], v[44:47]
    s_setprio 2
    s_waitcnt vmcnt(9)
    s_waitcnt lgkmcnt(8)
    v_mfma_f32_16x16x32_bf16 v[0:3], v[232:235], v[60:63], v[0:3]
L_stub87:
    s_cbranch_execz L_dry_back
    s_add_u32 s53, s63, 2
    s_and_b32 s53, s53, 7
    s_lshl_b32 s53, s53, 10
    s_add_u32 s53, s53, s49
    v_mfma_f32_16x16x32_bf16 v[4:7], v[232:235], v[64:67], v[4:7]
    buffer_load_dwordx4 v[48:51], v253, s[36:39], s53 offen sc1
    v_mfma_f32_16x16x32_bf16 v[8:11], v[232:235], v[68:71], v[8:11]
    s_add_u32 s53, s53, 131072
    buffer_load_dwordx4 v[52:55], v253, s[36:39], s53 offen sc1
    v_mfma_f32_16x16x32_bf16 v[12:15], v[236:239], v[60:63], v[12:15]
    s_add_u32 s53, s53, 131072
    buffer_load_dwordx4 v[56:59], v253, s[36:39], s53 offen sc1
    v_mfma_f32_16x16x32_bf16 v[16:19], v[236:239], v[64:67], v[16:19]
    v_mfma_f32_16x16x32_bf16 v[20:23], v[236:239], v[68:71], v[20:23]
    v_mfma_f32_16x16x32_bf16 v[24:27], v[240:243], v[60:63], v[24:27]
    v_mfma_f32_16x16x32_bf16 v[28:31], v[240:243], v[64:67], v[28:31]
    v_mfma_f32_16x16x32_bf16 v[32:35], v[240:243], v[68:71], v[32:35]
    v_mfma_f32_16x16x32_bf16 v[36:39], v[244:247], v[60:63], v[36:39]
    v_mfma_f32_16x16x32_bf16 v[40:43], v[244:247], v[64:67], v[40:43]
    v_mfma_f32_16x16x32_bf16 v[44:47], v[244:247], v[68:71], v[44:47]
    s_setprio 2
    s_waitcnt vmcnt(9)
    s_waitcnt lgkmcnt(0)
    v_mfma_f32_16x16x32_bf16 v[0:3], v[108:111], v[72:75], v[0:3]
    s_add_u32 s53, s63, 3
    s_and_b32 s53, s53, 7
    s_lshl_b32 s53, s53, 10
    s_add_u32 s53, s53, s49
    v_mfma_f32_16x16x32_bf16 v[4:7], v[108:111], v[76:79], v[4:7]
    buffer_load_dwordx4 v[60:63], v253, s[36:39], s53 offen sc1
    v_mfma_f32_16x16x32_bf16 v[8:11], v[108:111], v[80:83], v[8:11]
    s_add_u32 s53, s53, 131072
    buffer_load_dwordx4 v[64:67], v253, s[36:39], s53 offen sc1
    v_mfma_f32_16x16x32_bf16 v[12:15], v[112:115], v[72:75], v[12:15]
    s_add_u32 s53, s53, 131072
    buffer_load_dwordx4 v[68:71], v253, s[36:39], s53 offen sc1
    v_mfma_f32_16x16x32_bf16 v[16:19], v[112:115], v[76:79], v[16:19]
L_stub88:
    s_cbranch_execz L_dry_back
    v_mfma_f32_16x16x32_bf16 v[20:23], v[112:115], v[80:83], v[20:23]
    v_mfma_f32_16x16x32_bf16 v[24:27], v[116:119], v[72:75], v[24:27]
    v_mfma_f32_16x16x32_bf16 v[28:31], v[116:119], v[76:79], v[28:31]
    v_mfma_f32_16x16x32_bf16 v[32:35], v[116:119], v[80:83], v[32:35]
    v_mfma_f32_16x16x32_bf16 v[36:39], v[120:123], v[72:75], v[36:39]
    v_mfma_f32_16x16x32_bf16 v[40:43], v[120:123], v[76:79], v[40:43]
    v_mfma_f32_16x16x32_bf16 v[44:47], v[120:123], v[80:83], v[44:47]
    v_add_u32 v135, s44, v253
    s_nop 6
    ds_write_b128 v135, v[0:3] offset:0
    ds_write_b128 v135, v[4:7] offset:1024
    ds_write_b128 v135, v[8:11] offset:2048
    ds_write_b128 v135, v[12:15] offset:3072
    ds_write_b128 v135, v[16:19] offset:4096
    ds_write_b128 v135, v[20:23] offset:5120
    ds_write_b128 v135, v[24:27] offset:6144
    ds_write_b128 v135, v[28:31] offset:7168
    ds_write_b128 v135, v[32:35] offset:8192
    ds_write_b128 v135, v[36:39] offset:9216
    ds_write_b128 v135, v[40:43] offset:10240
    ds_write_b128 v135, v[44:47] offset:11264
    v_lshlrev_b32 v129, 14, v255
    v_add_u32 v129, 98304, v129
    s_mov_b64 exec, 15
    ds_add_u32 v129, v134
    s_mov_b64 exec, -1
    s_setprio 1
    s_waitcnt vmcnt(9)
    v_mfma_f32_16x16x32_bf16 v[0:3], v[136:139], v[84:87], 0
    s_add_u32 s53, s63, 4
    s_and_b32 s53, s53, 7
    s_lshl_b32 s53, s53, 10
    s_add_u32 s53, s53, s49
    v_mfma_f32_16x16x32_bf16 v[4:7], v[136:139], v[88:91], 0
    buffer_load_dwordx4 v[72:75], v253, s[36:39], s53 offen sc1
    v_mfma_f32_16x16x32_bf16 v[8:11], v[136:139], v[92:95], 0
    s_add_u32 s53, s53, 131072
L_stub89:
    s_cbranch_execz L_dry_back
    buffer_load_dwordx4 v[76:79], v253, s[36:39], s53 offen sc1
    v_mfma_f32_16x16x32_bf16 v[12:15], v[140:143], v[84:87], 0
    s_add_u32 s53, s53, 131072
    buffer_load_dwordx4 v[80:83], v253, s[36:39], s53 offen sc1
    v_mfma_f32_16x16x32_bf16 v[16:19], v[140:143], v[88:91], 0
    v_mfma_f32_16x16x32_bf16 v[20:23], v[140:143], v[92:95], 0
    v_mfma_f32_16x16x32_bf16 v[24:27], v[144:147], v[84:87], 0
    v_mfma_f32_16x16x32_bf16 v[28:31], v[144:147], v[88:91], 0
    v_mfma_f32_16x16x32_bf16 v[32:35], v[144:147], v[92:95], 0
    v_mfma_f32_16x16x32_bf16 v[36:39], v[148:151], v[84:87], 0
    v_mfma_f32_16x16x32_bf16 v[40:43], v[148:151], v[88:91], 0
    v_mfma_f32_16x16x32_bf16 v[44:47], v[148:151], v[92:95], 0
    s_setprio 1
    s_waitcnt vmcnt(9)
    v_mfma_f32_16x16x32_bf16 v[0:3], v[152:155], v[96:99], v[0:3]
    s_add_u32 s53, s63, 5
    s_and_b32 s53, s53, 7
    s_lshl_b32 s53, s53, 10
    s_add_u32 s53, s53, s49
    v_mfma_f32_16x16x32_bf16 v[4:7], v[152:155], v[100:103], v[4:7]
    buffer_load_dwordx4 v[84:87], v253, s[36:39], s53 offen sc1
    v_mfma_f32_16x16x32_bf16 v[8:11], v[152:155], v[104:107], v[8:11]
    s_add_u32 s53, s53, 131072
    buffer_load_dwordx4 v[88:91], v253, s[36:39], s53 offen sc1
    v_mfma_f32_16x16x32_bf16 v[12:15], v[156:159], v[96:99], v[12:15]
    s_add_u32 s53, s53, 131072
    buffer_load_dwordx4 v[92:95], v253, s[36:39], s53 offen sc1
    v_mfma_f32_16x16x32_bf16 v[16:19], v[156:159], v[100:103], v[16:19]
    v_mfma_f32_16x16x32_bf16 v[20:23], v[156:159], v[104:107], v[20:23]
    v_mfma_f32_16x16x32_bf16 v[24:27], v[160:163], v[96:99], v[24:27]
    v_mfma_f32_16x16x32_bf16 v[28:31], v[160:163], v[100:103], v[28:31]
    v_mfma_f32_16x16x32_bf16 v[32:35], v[160:163], v[104:107], v[32:35]
    v_mfma_f32_16x16x32_bf16 v[36:39], v[164:167], v[96:99], v[36:39]
    v_mfma_f32_16x16x32_bf16 v[40:43], v[164:167], v[100:103], v[40:43]
    v_mfma_f32_16x16x32_bf16 v[44:47], v[164:167], v[104:107], v[44:47]
L_stub90:
    s_cbranch_execz L_dry_back
    s_setprio 1
    s_waitcnt vmcnt(9)
    v_mfma_f32_16x16x32_bf16 v[0:3], v[168:171], v[48:51], v[0:3]
    s_add_u32 s53, s63, 6
    s_and_b32 s53, s53, 7
    s_lshl_b32 s53, s53, 10
    s_add_u32 s53, s53, s49
    v_mfma_f32_16x16x32_bf16 v[4:7], v[168:171], v[52:55], v[4:7]
    buffer_load_dwordx4 v[96:99], v253, s[36:39], s53 offen sc1
    v_mfma_f32_16x16x32_bf16 v[8:11], v[168:171], v[56:59], v[8:11]
    s_add_u32 s53, s53, 131072
    buffer_load_dwordx4 v[100:103], v253, s[36:39], s53 offen sc1
    v_mfma_f32_16x16x32_bf16 v[12:15], v[172:175], v[48:51], v[12:15]
    s_add_u32 s53, s53, 131072
    buffer_load_dwordx4 v[104:107], v253, s[36:39], s53 offen sc1
    v_mfma_f32_16x16x32_bf16 v[16:19], v[172:175], v[52:55], v[16:19]
    s_xor_b32 s43, s2, 1
    s_lshr_b32 s62, s43, 2
    s_lshl_b32 s62, s62, 7
    s_and_b32 s43, s43, 3
    s_lshl_b32 s43, s43, 4
    s_add_u32 s62, s62, s43
    s_add_u32 s62, s62, 12582912
    buffer_load_dword v133, v254, s[36:39], s62 offen sc1
    v_mfma_f32_16x16x32_bf16 v[20:23], v[172:175], v[56:59], v[20:23]
    v_mfma_f32_16x16x32_bf16 v[24:27], v[176:179], v[48:51], v[24:27]
    v_mfma_f32_16x16x32_bf16 v[28:31], v[176:179], v[52:55], v[28:31]
    v_mfma_f32_16x16x32_bf16 v[32:35], v[176:179], v[56:59], v[32:35]
    v_mfma_f32_16x16x32_bf16 v[36:39], v[180:183], v[48:51], v[36:39]
    v_mfma_f32_16x16x32_bf16 v[40:43], v[180:183], v[52:55], v[40:43]
    v_mfma_f32_16x16x32_bf16 v[44:47], v[180:183], v[56:59], v[44:47]
    s_setprio 1
    s_waitcnt vmcnt(10)
    v_mfma_f32_16x16x32_bf16 v[0:3], v[184:187], v[60:63], v[0:3]
    s_add_u32 s53, s63, 7
    s_and_b32 s53, s53, 7
    s_lshl_b32 s53, s53, 10
    s_add_u32 s53, s53, s49
    v_mfma_f32_16x16x32_bf16 v[4:7], v[184:187], v[64:67], v[4:7]
    buffer_load_dwordx4 v[48:51], v253, s[36:39], s53 offen sc1
L_stub91:
    s_cbranch_execz L_dry_back
    v_mfma_f32_16x16x32_bf16 v[8:11], v[184:187], v[68:71], v[8:11]
    s_add_u32 s53, s53, 131072
    buffer_load_dwordx4 v[52:55], v253, s[36:39], s53 offen sc1
    v_mfma_f32_16x16x32_bf16 v[12:15], v[188:191], v[60:63], v[12:15]
    s_add_u32 s53, s53, 131072
    buffer_load_dwordx4 v[56:59], v253, s[36:39], s53 offen sc1
    v_mfma_f32_16x16x32_bf16 v[16:19], v[188:191], v[64:67], v[16:19]
    v_mfma_f32_16x16x32_bf16 v[20:23], v[188:191], v[68:71], v[20:23]
    v_mfma_f32_16x16x32_bf16 v[24:27], v[192:195], v[60:63], v[24:27]
    v_mfma_f32_16x16x32_bf16 v[28:31], v[192:195], v[64:67], v[28:31]
    v_mfma_f32_16x16x32_bf16 v[32:35], v[192:195], v[68:71], v[32:35]
    v_mfma_f32_16x16x32_bf16 v[36:39], v[196:199], v[60:63], v[36:39]
    v_mfma_f32_16x16x32_bf16 v[40:43], v[196:199], v[64:67], v[40:43]
    v_mfma_f32_16x16x32_bf16 v[44:47], v[196:199], v[68:71], v[44:47]
    s_setprio 0
    s_waitcnt vmcnt(10)
    v_mfma_f32_16x16x32_bf16 v[0:3], v[200:203], v[72:75], v[0:3]
    s_waitcnt vmcnt(3)
    s_mov_b32 s53, 0
L_poll_m2:
    v_cmp_ne_u32 vcc, 1, v133
    s_cbranch_vccz L_polled_m2
    s_sleep 8
    buffer_load_dword v133, v254, s[36:39], s62 offen sc1
    s_add_u32 s53, s53, 1
    s_waitcnt vmcnt(0)
    s_cmp_lt_u32 s53, 0x40000
    s_cbranch_scc1 L_poll_m2
L_polled_m2:
    s_mov_b32 s53, 0
L_cnt:
    ds_read_b32 v133, v128
    s_add_u32 s53, s53, 1
    s_waitcnt lgkmcnt(0)
    v_cmp_ne_u32 vcc, 8, v133
    s_cbranch_vccz L_cntd
    s_sleep 1
    s_cmp_lt_u32 s53, 0x400000
    s_cbranch_scc1 L_cnt
L_cntd:
    s_mul_i32 s43, s40, 3072
    v_add_u32 v130, s43, v253
    v_add_u32 v131, 49152, v130
    s_xor_b32 s45, s2, 1
    s_mul_i32 s45, s45, 12288
L_stub92:
    s_cbranch_execz L_dry_back
    s_add_u32 s45, s45, s43
    s_add_u32 s45, s45, 13631488
    v_mfma_f32_16x16x32_bf16 v[4:7], v[200:203], v[76:79], v[4:7]
    ds_read_b128 v[136:139], v130 offset:0
    ds_read_b128 v[140:143], v130 offset:12288
    ds_read_b128 v[144:147], v130 offset:24576
    ds_read_b128 v[148:151], v130 offset:36864
    v_mfma_f32_16x16x32_bf16 v[8:11], v[200:203], v[80:83], v[8:11]
    ds_read_b128 v[152:155], v131 offset:0
    ds_read_b128 v[156:159], v131 offset:12288
    ds_read_b128 v[160:163], v131 offset:24576
    ds_read_b128 v[164:167], v131 offset:36864
    v_mfma_f32_16x16x32_bf16 v[12:15], v[204:207], v[72:75], v[12:15]
    v_mfma_f32_16x16x32_bf16 v[16:19], v[204:207], v[76:79], v[16:19]
    v_mfma_f32_16x16x32_bf16 v[20:23], v[204:207], v[80:83], v[20:23]
    v_mfma_f32_16x16x32_bf16 v[24:27], v[208:211], v[72:75], v[24:27]
    v_mfma_f32_16x16x32_bf16 v[28:31], v[208:211], v[76:79], v[28:31]
    v_mfma_f32_16x16x32_bf16 v[32:35], v[208:211], v[80:83], v[32:35]
    v_mfma_f32_16x16x32_bf16 v[36:39], v[212:215], v[72:75], v[36:39]
    v_mfma_f32_16x16x32_bf16 v[40:43], v[212:215], v[76:79], v[40:43]
    v_mfma_f32_16x16x32_bf16 v[44:47], v[212:215], v[80:83], v[44:47]
    s_setprio 0
    v_mfma_f32_16x16x32_bf16 v[0:3], v[216:219], v[84:87], v[0:3]
    s_waitcnt lgkmcnt(0)
    v_mfma_f32_16x16x32_bf16 v[4:7], v[216:219], v[88:91], v[4:7]
    v_add_f32 v136, v136, v152
    v_add_f32 v137, v137, v153
    v_add_f32 v138, v138, v154
    v_add_f32 v139, v139, v155
    v_mfma_f32_16x16x32_bf16 v[8:11], v[216:219], v[92:95], v[8:11]
    v_add_f32 v140, v140, v156
    v_add_f32 v141, v141, v157
    v_add_f32 v142, v142, v158
    v_add_f32 v143, v143, v159
    v_mfma_f32_16x16x32_bf16 v[12:15], v[220:223], v[84:87], v[12:15]
    v_add_f32 v144, v144, v160
    v_add_f32 v145, v145, v161
    v_add_f32 v146, v146, v162
    v_add_f32 v147, v147, v163
L_stub93:
    s_cbranch_execz L_dry_back
    v_mfma_f32_16x16x32_bf16 v[16:19], v[220:223], v[88:91], v[16:19]
    v_add_f32 v148, v148, v164
    v_add_f32 v149, v149, v165
    v_add_f32 v150, v150, v166
    v_add_f32 v151, v151, v167
    v_mfma_f32_16x16x32_bf16 v[20:23], v[220:223], v[92:95], v[20:23]
    v_add_f32 v136, v136, v144
    v_add_f32 v137, v137, v145
    v_add_f32 v138, v138, v146
    v_add_f32 v139, v139, v147
    v_mfma_f32_16x16x32_bf16 v[24:27], v[224:227], v[84:87], v[24:27]
    v_add_f32 v140, v140, v148
    v_add_f32 v141, v141, v149
    v_add_f32 v142, v142, v150
    v_add_f32 v143, v143, v151
    v_mfma_f32_16x16x32_bf16 v[28:31], v[224:227], v[88:91], v[28:31]
    v_add_f32 v136, v136, v140
    v_add_f32 v137, v137, v141
    v_add_f32 v138, v138, v142
    v_add_f32 v139, v139, v143
    v_mfma_f32_16x16x32_bf16 v[32:35], v[224:227], v[92:95], v[32:35]
    buffer_store_dwordx4 v[136:139], v253, s[36:39], s45 offen offset:0 sc1
    v_mfma_f32_16x16x32_bf16 v[36:39], v[228:231], v[84:87], v[36:39]
    ds_read_b128 v[168:171], v130 offset:1024
    ds_read_b128 v[172:175], v130 offset:13312
    ds_read_b128 v[176:179], v130 offset:25600
    ds_read_b128 v[180:183], v130 offset:37888
    v_mfma_f32_16x16x32_bf16 v[40:43], v[228:231], v[88:91], v[40:43]
    ds_read_b128 v[184:187], v131 offset:1024
    ds_read_b128 v[188:191], v131 offset:13312
    ds_read_b128 v[192:195], v131 offset:25600
    ds_read_b128 v[196:199], v131 offset:37888
    v_mfma_f32_16x16x32_bf16 v[44:47], v[228:231], v[92:95], v[44:47]
    s_setprio 0
    v_mfma_f32_16x16x32_bf16 v[0:3], v[232:235], v[96:99], v[0:3]
    s_waitcnt lgkmcnt(0)
    v_mfma_f32_16x16x32_bf16 v[4:7], v[232:235], v[100:103], v[4:7]
    v_add_f32 v168, v168, v184
    v_add_f32 v169, v169, v185
    v_add_f32 v170, v170, v186
    v_add_f32 v171, v171, v187
    v_mfma_f32_16x16x32_bf16 v[8:11], v[232:235], v[104:107], v[8:11]
    v_add_f32 v172, v172, v188
L_stub94:
    s_cbranch_execz L_dry_back
    v_add_f32 v173, v173, v189
    v_add_f32 v174, v174, v190
    v_add_f32 v175, v175, v191
    v_mfma_f32_16x16x32_bf16 v[12:15], v[236:239], v[96:99], v[12:15]
    v_add_f32 v176, v176, v192
    v_add_f32 v177, v177, v193
    v_add_f32 v178, v178, v194
    v_add_f32 v179, v179, v195
    v_mfma_f32_16x16x32_bf16 v[16:19], v[236:239], v[100:103], v[16:19]
    v_add_f32 v180, v180, v196
    v_add_f32 v181, v181, v197
    v_add_f32 v182, v182, v198
    v_add_f32 v183, v183, v199
    v_mfma_f32_16x16x32_bf16 v[20:23], v[236:239], v[104:107], v[20:23]
    v_add_f32 v168, v168, v176
    v_add_f32 v169, v169, v177
    v_add_f32 v170, v170, v178
    v_add_f32 v171, v171, v179
    v_mfma_f32_16x16x32_bf16 v[24:27], v[240:243], v[96:99], v[24:27]
    v_add_f32 v172, v172, v180
    v_add_f32 v173, v173, v181
    v_add_f32 v174, v174, v182
    v_add_f32 v175, v175, v183
    v_mfma_f32_16x16x32_bf16 v[28:31], v[240:243], v[100:103], v[28:31]
    v_add_f32 v168, v168, v172
    v_add_f32 v169, v169, v173
    v_add_f32 v170, v170, v174
    v_add_f32 v171, v171, v175
    v_mfma_f32_16x16x32_bf16 v[32:35], v[240:243], v[104:107], v[32:35]
    buffer_store_dwordx4 v[168:171], v253, s[36:39], s45 offen offset:1024 sc1
    v_mfma_f32_16x16x32_bf16 v[36:39], v[244:247], v[96:99], v[36:39]
    ds_read_b128 v[200:203], v130 offset:2048
    ds_read_b128 v[204:207], v130 offset:14336
    ds_read_b128 v[208:211], v130 offset:26624
    ds_read_b128 v[212:215], v130 offset:38912
    v_mfma_f32_16x16x32_bf16 v[40:43], v[244:247], v[100:103], v[40:43]
    ds_read_b128 v[216:219], v131 offset:2048
    ds_read_b128 v[220:223], v131 offset:14336
    ds_read_b128 v[224:227], v131 offset:26624
    ds_read_b128 v[228:231], v131 offset:38912
    v_mfma_f32_16x16x32_bf16 v[44:47], v[244:247], v[104:107], v[44:47]
    s_setprio 0
    s_waitcnt vmcnt(2)
    v_mfma_f32_16x16x32_bf16 v[0:3], v[108:111], v[48:51], v[0:3]
L_stub95:
    s_cbranch_execz L_dry_back
    s_waitcnt lgkmcnt(0)
    v_mfma_f32_16x16x32_bf16 v[4:7], v[108:111], v[52:55], v[4:7]
    v_add_f32 v200, v200, v216
    v_add_f32 v201, v201, v217
    v_add_f32 v202, v202, v218
    v_add_f32 v203, v203, v219
    v_mfma_f32_16x16x32_bf16 v[8:11], v[108:111], v[56:59], v[8:11]
    v_add_f32 v204, v204, v220
    v_add_f32 v205, v205, v221
    v_add_f32 v206, v206, v222
    v_add_f32 v207, v207, v223
    v_mfma_f32_16x16x32_bf16 v[12:15], v[112:115], v[48:51], v[12:15]
    v_add_f32 v208, v208, v224
    v_add_f32 v209, v209, v225
    v_add_f32 v210, v210, v226
    v_add_f32 v211, v211, v227
    v_mfma_f32_16x16x32_bf16 v[16:19], v[112:115], v[52:55], v[16:19]
    v_add_f32 v212, v212, v228
    v_add_f32 v213, v213, v229
    v_add_f32 v214, v214, v230
    v_add_f32 v215, v215, v231
    v_mfma_f32_16x16x32_bf16 v[20:23], v[112:115], v[56:59], v[20:23]
    v_add_f32 v200, v200, v208
    v_add_f32 v201, v201, v209
    v_add_f32 v202, v202, v210
    v_add_f32 v203, v203, v211
    v_mfma_f32_16x16x32_bf16 v[24:27], v[116:119], v[48:51], v[24:27]
    v_add_f32 v204, v204, v212
    v_add_f32 v205, v205, v213
    v_add_f32 v206, v206, v214
    v_add_f32 v207, v207, v215
    v_mfma_f32_16x16x32_bf16 v[28:31], v[116:119], v[52:55], v[28:31]
    v_add_f32 v200, v200, v204
    v_add_f32 v201, v201, v205
    v_add_f32 v202, v202, v206
    v_add_f32 v203, v203, v207
    v_mfma_f32_16x16x32_bf16 v[32:35], v[116:119], v[56:59], v[32:35]
    buffer_store_dwordx4 v[200:203], v253, s[36:39], s45 offen offset:2048 sc1
    v_mfma_f32_16x16x32_bf16 v[36:39], v[120:123], v[48:51], v[36:39]
    v_mfma_f32_16x16x32_bf16 v[40:43], v[120:123], v[52:55], v[40:43]
    v_mfma_f32_16x16x32_bf16 v[44:47], v[120:123], v[56:59], v[44:47]
    s_lshl_b32 s46, s40, 14
    s_add_u32 s46, s46, 98304
    s_branch L_tail_fin
L_tail_fin:
    v_add_u32 v240, s46, v253
    s_mov_b32 s24, s14
    s_mov_b32 s25, s15
    s_mov_b32 s26, 1474560
    s_mov_b32 s27, 0x20000
L_stub96:
    s_cbranch_execz L_dry_back
    ds_write_b128 v240, v[0:3] offset:0
    ds_write_b128 v240, v[4:7] offset:1024
    ds_write_b128 v240, v[8:11] offset:2048
    ds_write_b128 v240, v[12:15] offset:3072
    ds_write_b128 v240, v[16:19] offset:4096
    ds_write_b128 v240, v[20:23] offset:5120
    ds_write_b128 v240, v[24:27] offset:6144
    ds_write_b128 v240, v[28:31] offset:7168
    s_lshl_b32 s43, s40, 11
    v_add_u32 v240, s43, v253
    v_add_u32 v241, 49152, v240
    s_xor_b32 s45, s2, 1
    s_mul_i32 s45, s45, 12288
    s_add_u32 s45, s45, s43
    s_add_u32 s45, s45, 13631488
    s_waitcnt lgkmcnt(0)
    s_barrier
    ds_write_b128 v135, v[32:35] offset:0
    ds_write_b128 v135, v[36:39] offset:1024
    ds_write_b128 v135, v[40:43] offset:2048
    ds_write_b128 v135, v[44:47] offset:3072
    s_sub_u32 s47, s40, 2
    s_cmp_lt_u32 s40, 4
    s_cselect_b32 s47, s40, s47
    s_lshl_b32 s46, s47, 11
    s_mul_i32 s45, s2, 12288
    s_add_u32 s45, s45, s46
    s_add_u32 s45, s45, 13631488
    buffer_load_dwordx4 v[48:51], v253, s[36:39], s45 offen offset:0 sc1
    buffer_load_dwordx4 v[52:55], v253, s[36:39], s45 offen offset:1024 sc1
    s_waitcnt lgkmcnt(0)
    s_barrier
    s_lshr_b32 s43, s40, 1
    s_cmp_eq_u32 s43, 2
    s_cbranch_scc1 L_fin
    s_cmp_lt_u32 s40, 4
    s_cbranch_scc0 L_f_hi
    s_add_u32 s43, s46, 98304
    v_add_u32 v240, s43, v253
    ds_read_b128 v[64:67], v240 offset:0
    ds_read_b128 v[68:71], v240 offset:8192
L_stub97:
    s_cbranch_execz L_dry_back
    ds_read_b128 v[72:75], v240 offset:16384
    ds_read_b128 v[76:79], v240 offset:24576
    ds_read_b128 v[80:83], v240 offset:32768
    ds_read_b128 v[84:87], v240 offset:40960
    ds_read_b128 v[88:91], v240 offset:49152
    ds_read_b128 v[92:95], v240 offset:57344
    s_waitcnt lgkmcnt(4)
    ds_read_b128 v[96:99], v240 offset:1024
    ds_read_b128 v[100:103], v240 offset:9216
    ds_read_b128 v[104:107], v240 offset:17408
    ds_read_b128 v[108:111], v240 offset:25600
    ds_read_b128 v[112:115], v240 offset:33792
    ds_read_b128 v[116:119], v240 offset:41984
    ds_read_b128 v[120:123], v240 offset:50176
    ds_read_b128 v[124:127], v240 offset:58368
    s_branch L_f_sum
L_f_hi:
    s_sub_u32 s43, s46, 8192
    v_add_u32 v240, s43, v253
    v_add_u32 v241, 49152, v240
    ds_read_b128 v[64:67], v240 offset:0
    ds_read_b128 v[68:71], v240 offset:12288
    ds_read_b128 v[72:75], v240 offset:24576
    ds_read_b128 v[76:79], v240 offset:36864
    ds_read_b128 v[80:83], v241 offset:0
    ds_read_b128 v[84:87], v241 offset:12288
    ds_read_b128 v[88:91], v241 offset:24576
    ds_read_b128 v[92:95], v241 offset:36864
    s_waitcnt lgkmcnt(4)
    ds_read_b128 v[96:99], v240 offset:1024
    ds_read_b128 v[100:103], v240 offset:13312
    ds_read_b128 v[104:107], v240 offset:25600
    ds_read_b128 v[108:111], v240 offset:37888
    ds_read_b128 v[112:115], v241 offset:1024
L_stub98:
    s_cbranch_execz L_dry_back
    ds_read_b128 v[116:119], v241 offset:13312
    ds_read_b128 v[120:123], v241 offset:25600
    ds_read_b128 v[124:127], v241 offset:37888
L_f_sum:
    v_and_b32 v242, 15, v255
    v_mul_u32_u24 v242, 1280, v242
    v_lshrrev_b32 v243, 4, v255
    v_lshl_add_u32 v242, v243, 3, v242
    s_lshl_b32 s46, s47, 1
    s_add_u32 s46, s46, 0
    s_mul_i32 s52, s46, 22
    s_lshr_b32 s52, s52, 6
    s_mul_i32 s48, s52, 3
    s_sub_u32 s48, s46, s48
    s_mul_i32 s56, s51, 3
    s_add_u32 s56, s56, s48
    s_mul_i32 s56, s56, 20480
    s_lshl_b32 s50, s61, 7
    s_add_u32 s56, s56, s50
    s_lshl_b32 s50, s52, 5
    s_add_u32 s56, s56, s50
    s_waitcnt lgkmcnt(8)
    v_add_f32 v64, v64, v80
    v_add_f32 v65, v65, v81
    v_add_f32 v66, v66, v82
    v_add_f32 v67, v67, v83
    v_add_f32 v68, v68, v84
    v_add_f32 v69, v69, v85
    v_add_f32 v70, v70, v86
    v_add_f32 v71, v71, v87
    v_add_f32 v72, v72, v88
    v_add_f32 v73, v73, v89
    v_add_f32 v74, v74, v90
    v_add_f32 v75, v75, v91
    v_add_f32 v76, v76, v92
    v_add_f32 v77, v77, v93
    v_add_f32 v78, v78, v94
    v_add_f32 v79, v79, v95
    v_add_f32 v64, v64, v72
    v_add_f32 v65, v65, v73
    v_add_f32 v66, v66, v74
    v_add_f32 v67, v67, v75
    v_add_f32 v68, v68, v76
    v_add_f32 v69, v69, v77
    v_add_f32 v70, v70, v78
    v_add_f32 v71, v71, v79
    v_add_f32 v64, v64, v68
    v_add_f32 v65, v65, v69
    v_add_f32 v66, v66, v70
    v_add_f32 v67, v67, v71
    s_lshl_b32 s46, s47, 1
    s_add_u32 s46, s46, 1
    s_mul_i32 s52, s46, 22
    s_lshr_b32 s52, s52, 6
    s_mul_i32 s48, s52, 3
    s_sub_u32 s48, s46, s48
    s_mul_i32 s57, s51, 3
    s_add_u32 s57, s57, s48
L_stub99:
    s_cbranch_execz L_dry_back
    s_mul_i32 s57, s57, 20480
    s_lshl_b32 s50, s61, 7
    s_add_u32 s57, s57, s50
    s_lshl_b32 s50, s52, 5
    s_add_u32 s57, s57, s50
    s_waitcnt lgkmcnt(0)
    v_add_f32 v96, v96, v112
    v_add_f32 v97, v97, v113
    v_add_f32 v98, v98, v114
    v_add_f32 v99, v99, v115
    v_add_f32 v100, v100, v116
    v_add_f32 v101, v101, v117
    v_add_f32 v102, v102, v118
    v_add_f32 v103, v103, v119
    v_add_f32 v104, v104, v120
    v_add_f32 v105, v105, v121
    v_add_f32 v106, v106, v122
    v_add_f32 v107, v107, v123
    v_add_f32 v108, v108, v124
    v_add_f32 v109, v109, v125
    v_add_f32 v110, v110, v126
    v_add_f32 v111, v111, v127
    v_add_f32 v96, v96, v104
    v_add_f32 v97, v97, v105
    v_add_f32 v98, v98, v106
    v_add_f32 v99, v99, v107
    v_add_f32 v100, v100, v108
    v_add_f32 v101, v101, v109
    v_add_f32 v102, v102, v110
    v_add_f32 v103, v103, v111
    v_add_f32 v96, v96, v100
    v_add_f32 v97, v97, v101
    v_add_f32 v98, v98, v102
    v_add_f32 v99, v99, v103
    s_mov_b32 s53, 0
L_ppoll:
    s_waitcnt vmcnt(0)
    v_max_u32 v56, v48, v49
    v_max3_u32 v56, v56, v50, v51
    v_max3_u32 v56, v56, v52, v53
    v_max3_u32 v56, v56, v54, v55
    v_cmp_eq_u32 vcc, -1, v56
    s_cbranch_vccz L_ppolled
    s_add_u32 s53, s53, 1
    s_cmp_ge_u32 s53, 0x40000
    s_cbranch_scc1 L_ppolled
    buffer_load_dwordx4 v[48:51], v253, s[36:39], s45 offen offset:0 sc1
    buffer_load_dwordx4 v[52:55], v253, s[36:39], s45 offen offset:1024 sc1
    s_branch L_ppoll
L_ppolled:
    v_add_f32 v64, v64, v48
    v_add_f32 v65, v65, v49
    v_add_f32 v66, v66, v50
    v_add_f32 v67, v67, v51
    v_cvt_pk_bf16_f32 v128, v64, v65
    v_cvt_pk_bf16_f32 v129, v66, v67
L_stub100:
    s_cbranch_execz L_dry_back
    buffer_store_dwordx2 v[128:129], v242, s[24:27], s56 offen
    v_add_f32 v96, v96, v52
    v_add_f32 v97, v97, v53
    v_add_f32 v98, v98, v54
    v_add_f32 v99, v99, v55
    v_cvt_pk_bf16_f32 v130, v96, v97
    v_cvt_pk_bf16_f32 v131, v98, v99
    buffer_store_dwordx2 v[130:131], v242, s[24:27], s57 offen
L_fin:
L_end:
    s_endpgm
.section .rodata,"a"
.p2align 6
.amdhsa_kernel standalone__gqa_block_cached__near_ridge_kernel
  .amdhsa_next_free_vgpr 256
  .amdhsa_next_free_sgpr 102
  .amdhsa_accum_offset 256
  .amdhsa_group_segment_fixed_size 0
  .amdhsa_kernarg_size 64
  .amdhsa_user_sgpr_count 2
  .amdhsa_user_sgpr_kernarg_segment_ptr 1
  .amdhsa_system_sgpr_workgroup_id_x 1
.end_amdhsa_kernel
```
